```python
import torch

def _softmax(x, axis=-1):
    return torch.softmax(x, dim=axis)
def _gelu(x):
    return torch.nn.functional.gelu(x, approximate="tanh")
def _silu(x):
    return torch.nn.functional.silu(x)
def _sigmoid(x):
    return torch.sigmoid(x)
def _layernorm(x, axis=-1, eps=1e-5):
    m = x.mean(dim=axis, keepdim=True)
    v = x.var(dim=axis, keepdim=True, unbiased=False)
    return (x - m) / torch.sqrt(v + eps)
def _scatter_add(tgt, idx, src, axis=0):
    return tgt.clone().index_add_(axis, idx, src)
def _segment_sum(src, seg, n):
    out = torch.zeros((n,) + src.shape[1:], dtype=src.dtype)
    return out.index_add_(0, seg, src)
def _pad(x, pw):
    flat = tuple(v for pair in reversed(pw) for v in pair)
    return torch.nn.functional.pad(x, flat)

kernel_name = 'parallel_sum__mha_block_cached__dense_activation_silu__decode'

def setup_inputs():

    _w = (lambda a: (lambda t: t.to(torch.bfloat16) if t.is_floating_point() else t)(torch.as_tensor(a)))
    def _A_setup():
        B, Sq, D = 4, 1, 512
        H, Sk, Dh = 32, 4096, 128
        return {
            "x": _w((lambda *s: torch.randn(*s, dtype=torch.bfloat16) * 0.05)(B, Sq, D)),
            "k_cache": _w((lambda *s: torch.randn(*s, dtype=torch.bfloat16) * 3.2)(B, H, Sk, Dh)),
            "v_cache": _w((lambda *s: torch.randn(*s, dtype=torch.bfloat16) * 0.8)(B, H, Sk, Dh)),
            "wq": _w((lambda *s: torch.randn(*s, dtype=torch.bfloat16) * 3.2)(D, H * Dh) * (D ** -0.5)),
            "wo": _w((lambda *s: torch.randn(*s, dtype=torch.bfloat16) * 0.8)(H * Dh, D) * ((H * Dh) ** -0.5)),
        }
    _A_in = _A_setup()

    def _B_setup():
        B, S, D, F = 4, 1, 512, 1792
        return {
            "x": _w((lambda *s: torch.randn(*s, dtype=torch.bfloat16) * 0.05)(B, S, D)),
            "w1": _w((lambda *s: torch.randn(*s, dtype=torch.bfloat16) * 3.2)(D, F) * (D ** -0.5)),
            "w2": _w((lambda *s: torch.randn(*s, dtype=torch.bfloat16) * 0.4)(F, D) * (F ** -0.5)),
        }
    _B_in = _B_setup()

    return {
        "A_x": _A_in["x"],
        "A_k_cache": _A_in["k_cache"],
        "A_v_cache": _A_in["v_cache"],
        "A_wq": _A_in["wq"],
        "A_wo": _A_in["wo"],
        "B_x": _B_in["x"],
        "B_w1": _B_in["w1"],
        "B_w2": _B_in["w2"],
    }

def reference(A_x, A_k_cache, A_v_cache, A_wq, A_wo, B_x, B_w1, B_w2):
    def _A_ref(x, k_cache, v_cache, wq, wo):
        B, Sq, D = x.shape
        H, Dh = 32, 128
        q = (lambda x, *d: x.permute(*d))((x @ wq).reshape(B, Sq, H, Dh), 0, 2, 1, 3)
        scores = torch.einsum("bhqd,bhkd->bhqk", q, k_cache) * (Dh ** -0.5)
        p = _softmax(scores, axis=-1)
        o = torch.einsum("bhqk,bhkd->bhqd", p, v_cache)
        return (lambda x, *d: x.permute(*d))(o, 0, 2, 1, 3).reshape(B, Sq, H * Dh) @ wo

    def _B_ref(x, w1, w2):
        h = torch.einsum("bsd,df->bsf", x, w1)
        h = _silu(h)
        out = torch.einsum("bsf,fd->bsd", h, w2)
        return out

    x = A_x
    xn = _layernorm(x, axis=-1)
    return x + _A_ref(xn, A_k_cache, A_v_cache, A_wq, A_wo) + _B_ref(xn, B_w1, B_w2)
```

```asm
; @launch grid=(256,1,1) block=(512,1,1) lds=9728
.amdgcn_target "amdgcn-amd-amdhsa--gfx950"
.text
.globl parallel_sum__mha_block_cached__dense_activation_silu__decode_kernel
.p2align 8
.type parallel_sum__mha_block_cached__dense_activation_silu__decode_kernel,@function
parallel_sum__mha_block_cached__dense_activation_silu__decode_kernel:
s_cmp_ge_u32 s2, 256
s_cbranch_scc1 L_end
s_load_dwordx4 s[8:11], s[0:1], 16
s_load_dwordx4 s[4:7], s[0:1], 0
s_load_dwordx2 s[22:23], s[0:1], 80
s_load_dwordx2 s[12:13], s[0:1], 32
s_load_dwordx4 s[16:19], s[0:1], 48
s_load_dwordx2 s[20:21], s[0:1], 64
s_load_dwordx2 s[14:15], s[0:1], 72
v_and_b32 v1, 63, v0
v_lshrrev_b32 v22, 6, v0
s_nop 0
v_readfirstlane_b32 s48, v22
s_and_b32 s49, s2, 7
s_lshr_b32 s50, s2, 3
s_and_b32 s51, s50, 1
s_bfe_u32 s52, s50, 0x20001
s_lshr_b32 s53, s50, 3
s_lshl_b32 s54, s49, 2
s_add_u32 s54, s54, s52
s_lshl_b32 s70, s53, 1
s_add_u32 s70, s70, s51
v_lshrrev_b32 v18, 4, v1
v_and_b32 v19, 15, v1
s_mov_b32 s62, 0xffff0000
s_cmp_ge_u32 s48, 4
s_cbranch_scc1 L_fpath
s_lshl_b32 s59, s48, 17
s_lshl_b32 s65, s54, 8
s_add_u32 s59, s59, s65
v_lshlrev_b32 v24, 13, v18
v_lshl_add_u32 v24, v19, 4, v24
v_add_u32 v24, s59, v24
s_waitcnt lgkmcnt(0)
s_or_b32 s59, s2, s48
s_cmp_lg_u32 s59, 0
s_cbranch_scc1 L_par_pubdone
s_getreg_b32 s59, hwreg(HW_REG_XCC_ID)
s_and_b32 s59, s59, 1
s_add_u32 s59, s59, 1
v_mov_b32 v26, 0
v_mov_b32 v27, s59
s_mov_b64 exec, 1
global_store_dword v26, v27, s[14:15] sc1
s_mov_b64 exec, -1
L_par_pubdone:
s_mov_b32 s32, s10
s_mov_b32 s33, s11
s_mov_b32 s34, 0x400000
s_mov_b32 s35, 0x20000
s_add_u32 s65, s70, 0
s_and_b32 s65, s65, 7
s_lshl_b32 s65, s65, 19
s_add_u32 s58, s65, 0
buffer_load_dwordx4 v[48:51], v24, s[32:35], s58 offen
s_add_u32 s58, s65, 32768
buffer_load_dwordx4 v[52:55], v24, s[32:35], s58 offen
s_add_u32 s58, s65, 65536
buffer_load_dwordx4 v[56:59], v24, s[32:35], s58 offen
s_add_u32 s58, s65, 98304
buffer_load_dwordx4 v[60:63], v24, s[32:35], s58 offen
s_add_u32 s65, s70, 1
s_and_b32 s65, s65, 7
s_lshl_b32 s65, s65, 19
s_add_u32 s58, s65, 0
buffer_load_dwordx4 v[64:67], v24, s[32:35], s58 offen
s_add_u32 s58, s65, 32768
buffer_load_dwordx4 v[68:71], v24, s[32:35], s58 offen
s_add_u32 s58, s65, 65536
buffer_load_dwordx4 v[72:75], v24, s[32:35], s58 offen
s_add_u32 s58, s65, 98304
buffer_load_dwordx4 v[76:79], v24, s[32:35], s58 offen
s_barrier
s_add_u32 s65, s70, 2
s_and_b32 s65, s65, 7
s_lshl_b32 s65, s65, 19
s_add_u32 s58, s65, 0
buffer_load_dwordx4 v[80:83], v24, s[32:35], s58 offen
s_add_u32 s58, s65, 32768
buffer_load_dwordx4 v[84:87], v24, s[32:35], s58 offen
s_add_u32 s58, s65, 65536
buffer_load_dwordx4 v[88:91], v24, s[32:35], s58 offen
s_add_u32 s58, s65, 98304
buffer_load_dwordx4 v[92:95], v24, s[32:35], s58 offen
s_add_u32 s65, s70, 3
s_and_b32 s65, s65, 7
s_lshl_b32 s65, s65, 19
s_add_u32 s58, s65, 0
buffer_load_dwordx4 v[96:99], v24, s[32:35], s58 offen
s_add_u32 s58, s65, 32768
buffer_load_dwordx4 v[100:103], v24, s[32:35], s58 offen
s_add_u32 s58, s65, 65536
buffer_load_dwordx4 v[104:107], v24, s[32:35], s58 offen
s_add_u32 s58, s65, 98304
buffer_load_dwordx4 v[108:111], v24, s[32:35], s58 offen
s_add_u32 s65, s70, 4
s_and_b32 s65, s65, 7
s_lshl_b32 s65, s65, 19
s_add_u32 s58, s65, 0
buffer_load_dwordx4 v[180:183], v24, s[32:35], s58 offen
s_add_u32 s58, s65, 32768
buffer_load_dwordx4 v[184:187], v24, s[32:35], s58 offen
s_add_u32 s58, s65, 65536
buffer_load_dwordx4 v[188:191], v24, s[32:35], s58 offen
s_add_u32 s58, s65, 98304
buffer_load_dwordx4 v[192:195], v24, s[32:35], s58 offen
s_add_u32 s65, s70, 5
s_and_b32 s65, s65, 7
s_lshl_b32 s65, s65, 19
s_add_u32 s58, s65, 0
buffer_load_dwordx4 v[196:199], v24, s[32:35], s58 offen
s_add_u32 s58, s65, 32768
buffer_load_dwordx4 v[200:203], v24, s[32:35], s58 offen
s_add_u32 s58, s65, 65536
buffer_load_dwordx4 v[204:207], v24, s[32:35], s58 offen
s_add_u32 s58, s65, 98304
buffer_load_dwordx4 v[208:211], v24, s[32:35], s58 offen
s_add_u32 s65, s70, 6
s_and_b32 s65, s65, 7
s_lshl_b32 s65, s65, 19
s_add_u32 s58, s65, 0
buffer_load_dwordx4 v[212:215], v24, s[32:35], s58 offen
s_add_u32 s58, s65, 32768
buffer_load_dwordx4 v[216:219], v24, s[32:35], s58 offen
s_add_u32 s58, s65, 65536
buffer_load_dwordx4 v[220:223], v24, s[32:35], s58 offen
s_add_u32 s58, s65, 98304
buffer_load_dwordx4 v[224:227], v24, s[32:35], s58 offen
v_mov_b32 v32, 0
v_mov_b32 v33, 1
s_waitcnt lgkmcnt(0)
s_mov_b64 exec, 1
ds_add_u32 v32, v33 offset:9612
s_mov_b64 exec, -1
s_add_u32 s65, s70, 7
s_and_b32 s65, s65, 7
s_lshl_b32 s65, s65, 19
s_add_u32 s58, s65, 0
buffer_load_dwordx4 v[228:231], v24, s[32:35], s58 offen
s_add_u32 s58, s65, 32768
buffer_load_dwordx4 v[232:235], v24, s[32:35], s58 offen
s_add_u32 s58, s65, 65536
buffer_load_dwordx4 v[236:239], v24, s[32:35], s58 offen
s_add_u32 s58, s65, 98304
buffer_load_dwordx4 v[240:243], v24, s[32:35], s58 offen
s_mov_b32 s24, s6
s_mov_b32 s25, s7
s_mov_b32 s26, 0x8000000
s_mov_b32 s27, 0x20000
s_mov_b32 s28, s8
s_mov_b32 s29, s9
s_mov_b32 s30, 0x8000000
s_mov_b32 s31, 0x20000
s_lshl_b32 s59, s53, 5
s_add_u32 s59, s59, s54
s_lshl_b32 s59, s59, 20
s_lshl_b32 s65, s51, 15
s_add_u32 s59, s59, s65
s_lshl_b32 s65, s48, 12
s_add_u32 s59, s59, s65
v_lshlrev_b32 v29, 4, v1
v_add_u32 v2, s59, v29
s_and_b32 s55, s50, 7
s_lshl_b32 s56, s49, 3
s_add_u32 s56, s56, s55
s_lshr_b32 s57, s49, 1
s_mul_i32 s57, s57, 7
s_add_u32 s57, s57, s55
s_and_b32 s66, s48, 3
s_lshl_b32 s65, s53, 8
s_load_dword s64, s[22:23], s65
v_lshrrev_b32 v113, 3, v19
v_lshl_add_u32 v113, v113, 2, v18
s_lshl_b32 s59, s66, 7
v_add_u32 v113, s59, v113
v_mul_u32_u24 v113, 3584, v113
v_and_b32 v29, 7, v19
v_lshl_add_u32 v113, v29, 4, v113
s_lshl_b32 s59, s57, 7
v_add_u32 v113, s59, v113
s_lshl_b32 s59, s57, 16
s_lshl_b32 s65, s48, 8
s_add_u32 s59, s59, s65
v_lshlrev_b32 v114, 14, v18
v_lshl_add_u32 v114, v19, 4, v114
v_add_u32 v114, s59, v114
s_lshl_b32 s59, s54, 17
s_lshl_b32 s65, s48, 7
s_add_u32 s59, s59, s65
v_lshlrev_b32 v21, 15, v18
v_lshl_add_u32 v21, v19, 3, v21
v_add_u32 v21, s59, v21
v_lshl_add_u32 v20, v19, 2, v18
v_lshlrev_b32 v20, 3, v20
s_lshl_b32 s59, s53, 6
s_add_u32 s59, s59, s56
s_lshl_b32 s59, s59, 12
s_lshl_b32 s65, s48, 9
s_add_u32 s59, s59, s65
v_lshrrev_b32 v115, 1, v18
v_lshl_add_u32 v115, v19, 1, v115
v_lshlrev_b32 v115, 4, v115
v_add_u32 v115, s59, v115
s_mov_b32 s60, 0x3db504f3
s_mov_b32 s61, 0x3fb8aa3b
s_mov_b32 s68, 0x05040100
s_mov_b32 s69, 0x07060302
s_mov_b32 s36, s12
s_mov_b32 s37, s13
s_mov_b32 s38, 0x400000
s_mov_b32 s39, 0x20000
s_mov_b32 s40, s16
s_mov_b32 s41, s17
s_mov_b32 s42, 0x1c0000
s_mov_b32 s43, 0x20000
s_mov_b32 s44, s18
s_mov_b32 s45, s19
s_mov_b32 s46, 0x1c0000
s_mov_b32 s47, 0x20000
s_cmp_eq_u32 s55, 7
s_cselect_b32 s42, 0, s42
s_cselect_b32 s46, 0, s46
s_lshl_b32 s59, s53, 10
s_lshl_b32 s65, s56, 4
s_add_u32 s65, s65, s59
v_and_b32 v29, 7, v1
v_lshlrev_b32 v29, 1, v29
v_add_u32 v29, s65, v29
global_load_ushort v3, v29, s[4:5]
s_lshl_b32 s65, s48, 6
v_lshrrev_b32 v36, 2, v19
v_add_u32 v36, s70, v36
v_add_u32 v37, 4, v36
v_and_b32 v36, 7, v36
v_and_b32 v37, 7, v37
v_and_b32 v38, 3, v19
v_lshl_add_u32 v38, v38, 2, v18
v_lshlrev_b32 v38, 2, v38
v_add_u32 v38, s65, v38
v_lshl_add_u32 v36, v36, 8, v38
v_lshl_add_u32 v37, v37, 8, v38
v_mov_b32 v8, 0
v_mov_b32 v9, 0
v_mov_b32 v10, 0
v_mov_b32 v11, 0
v_mov_b32 v12, 0
v_mov_b32 v13, 0
v_mov_b32 v14, 0
v_mov_b32 v15, 0
v_mov_b32 v38, 0
L_fl_1:
ds_read_b32 v39, v38 offset:9600
s_waitcnt lgkmcnt(0)
v_readfirstlane_b32 s59, v39
s_cmp_ge_u32 s59, 1
s_cbranch_scc1 L_fl_1_ok
s_branch L_fl_1
L_fl_1_ok:
ds_read_b32 v22, v36 offset:0
ds_read_b32 v23, v37 offset:0
s_waitcnt lgkmcnt(0)
v_lshlrev_b32 v24, 16, v22
v_lshlrev_b32 v25, 16, v23
L_segA:
s_waitcnt vmcnt(17)
v_dot2c_f32_bf16_dpp v8, v22, v48 row_newbcast:0 row_mask:0xf bank_mask:0xf
v_dot2c_f32_bf16_dpp v9, v24, v48 row_newbcast:0 row_mask:0xf bank_mask:0xf
v_dot2c_f32_bf16_dpp v10, v22, v49 row_newbcast:0 row_mask:0xf bank_mask:0xf
v_dot2c_f32_bf16_dpp v11, v24, v49 row_newbcast:0 row_mask:0xf bank_mask:0xf
v_dot2c_f32_bf16_dpp v12, v22, v50 row_newbcast:0 row_mask:0xf bank_mask:0xf
v_dot2c_f32_bf16_dpp v13, v24, v50 row_newbcast:0 row_mask:0xf bank_mask:0xf
v_dot2c_f32_bf16_dpp v14, v22, v51 row_newbcast:0 row_mask:0xf bank_mask:0xf
v_dot2c_f32_bf16_dpp v15, v24, v51 row_newbcast:0 row_mask:0xf bank_mask:0xf
v_dot2c_f32_bf16_dpp v8, v22, v52 row_newbcast:1 row_mask:0xf bank_mask:0xf
v_dot2c_f32_bf16_dpp v9, v24, v52 row_newbcast:1 row_mask:0xf bank_mask:0xf
v_dot2c_f32_bf16_dpp v10, v22, v53 row_newbcast:1 row_mask:0xf bank_mask:0xf
v_dot2c_f32_bf16_dpp v11, v24, v53 row_newbcast:1 row_mask:0xf bank_mask:0xf
v_dot2c_f32_bf16_dpp v12, v22, v54 row_newbcast:1 row_mask:0xf bank_mask:0xf
v_dot2c_f32_bf16_dpp v13, v24, v54 row_newbcast:1 row_mask:0xf bank_mask:0xf
v_dot2c_f32_bf16_dpp v14, v22, v55 row_newbcast:1 row_mask:0xf bank_mask:0xf
v_dot2c_f32_bf16_dpp v15, v24, v55 row_newbcast:1 row_mask:0xf bank_mask:0xf
v_dot2c_f32_bf16_dpp v8, v22, v56 row_newbcast:2 row_mask:0xf bank_mask:0xf
v_dot2c_f32_bf16_dpp v9, v24, v56 row_newbcast:2 row_mask:0xf bank_mask:0xf
v_dot2c_f32_bf16_dpp v10, v22, v57 row_newbcast:2 row_mask:0xf bank_mask:0xf
v_dot2c_f32_bf16_dpp v11, v24, v57 row_newbcast:2 row_mask:0xf bank_mask:0xf
v_dot2c_f32_bf16_dpp v12, v22, v58 row_newbcast:2 row_mask:0xf bank_mask:0xf
v_dot2c_f32_bf16_dpp v13, v24, v58 row_newbcast:2 row_mask:0xf bank_mask:0xf
v_dot2c_f32_bf16_dpp v14, v22, v59 row_newbcast:2 row_mask:0xf bank_mask:0xf
v_dot2c_f32_bf16_dpp v15, v24, v59 row_newbcast:2 row_mask:0xf bank_mask:0xf
v_dot2c_f32_bf16_dpp v8, v22, v60 row_newbcast:3 row_mask:0xf bank_mask:0xf
v_dot2c_f32_bf16_dpp v9, v24, v60 row_newbcast:3 row_mask:0xf bank_mask:0xf
v_dot2c_f32_bf16_dpp v10, v22, v61 row_newbcast:3 row_mask:0xf bank_mask:0xf
v_dot2c_f32_bf16_dpp v11, v24, v61 row_newbcast:3 row_mask:0xf bank_mask:0xf
v_dot2c_f32_bf16_dpp v12, v22, v62 row_newbcast:3 row_mask:0xf bank_mask:0xf
v_dot2c_f32_bf16_dpp v13, v24, v62 row_newbcast:3 row_mask:0xf bank_mask:0xf
v_dot2c_f32_bf16_dpp v14, v22, v63 row_newbcast:3 row_mask:0xf bank_mask:0xf
v_dot2c_f32_bf16_dpp v15, v24, v63 row_newbcast:3 row_mask:0xf bank_mask:0xf
v_dot2c_f32_bf16_dpp v8, v22, v64 row_newbcast:4 row_mask:0xf bank_mask:0xf
v_dot2c_f32_bf16_dpp v9, v24, v64 row_newbcast:4 row_mask:0xf bank_mask:0xf
v_dot2c_f32_bf16_dpp v10, v22, v65 row_newbcast:4 row_mask:0xf bank_mask:0xf
v_dot2c_f32_bf16_dpp v11, v24, v65 row_newbcast:4 row_mask:0xf bank_mask:0xf
v_dot2c_f32_bf16_dpp v12, v22, v66 row_newbcast:4 row_mask:0xf bank_mask:0xf
v_dot2c_f32_bf16_dpp v13, v24, v66 row_newbcast:4 row_mask:0xf bank_mask:0xf
v_dot2c_f32_bf16_dpp v14, v22, v67 row_newbcast:4 row_mask:0xf bank_mask:0xf
v_dot2c_f32_bf16_dpp v15, v24, v67 row_newbcast:4 row_mask:0xf bank_mask:0xf
v_dot2c_f32_bf16_dpp v8, v22, v68 row_newbcast:5 row_mask:0xf bank_mask:0xf
v_dot2c_f32_bf16_dpp v9, v24, v68 row_newbcast:5 row_mask:0xf bank_mask:0xf
v_dot2c_f32_bf16_dpp v10, v22, v69 row_newbcast:5 row_mask:0xf bank_mask:0xf
v_dot2c_f32_bf16_dpp v11, v24, v69 row_newbcast:5 row_mask:0xf bank_mask:0xf
v_dot2c_f32_bf16_dpp v12, v22, v70 row_newbcast:5 row_mask:0xf bank_mask:0xf
v_dot2c_f32_bf16_dpp v13, v24, v70 row_newbcast:5 row_mask:0xf bank_mask:0xf
v_dot2c_f32_bf16_dpp v14, v22, v71 row_newbcast:5 row_mask:0xf bank_mask:0xf
v_dot2c_f32_bf16_dpp v15, v24, v71 row_newbcast:5 row_mask:0xf bank_mask:0xf
v_dot2c_f32_bf16_dpp v8, v22, v72 row_newbcast:6 row_mask:0xf bank_mask:0xf
v_dot2c_f32_bf16_dpp v9, v24, v72 row_newbcast:6 row_mask:0xf bank_mask:0xf
v_dot2c_f32_bf16_dpp v10, v22, v73 row_newbcast:6 row_mask:0xf bank_mask:0xf
v_dot2c_f32_bf16_dpp v11, v24, v73 row_newbcast:6 row_mask:0xf bank_mask:0xf
v_dot2c_f32_bf16_dpp v12, v22, v74 row_newbcast:6 row_mask:0xf bank_mask:0xf
v_dot2c_f32_bf16_dpp v13, v24, v74 row_newbcast:6 row_mask:0xf bank_mask:0xf
v_dot2c_f32_bf16_dpp v14, v22, v75 row_newbcast:6 row_mask:0xf bank_mask:0xf
v_dot2c_f32_bf16_dpp v15, v24, v75 row_newbcast:6 row_mask:0xf bank_mask:0xf
v_dot2c_f32_bf16_dpp v8, v22, v76 row_newbcast:7 row_mask:0xf bank_mask:0xf
v_dot2c_f32_bf16_dpp v9, v24, v76 row_newbcast:7 row_mask:0xf bank_mask:0xf
v_dot2c_f32_bf16_dpp v10, v22, v77 row_newbcast:7 row_mask:0xf bank_mask:0xf
v_dot2c_f32_bf16_dpp v11, v24, v77 row_newbcast:7 row_mask:0xf bank_mask:0xf
v_dot2c_f32_bf16_dpp v12, v22, v78 row_newbcast:7 row_mask:0xf bank_mask:0xf
v_dot2c_f32_bf16_dpp v13, v24, v78 row_newbcast:7 row_mask:0xf bank_mask:0xf
v_dot2c_f32_bf16_dpp v14, v22, v79 row_newbcast:7 row_mask:0xf bank_mask:0xf
v_dot2c_f32_bf16_dpp v15, v24, v79 row_newbcast:7 row_mask:0xf bank_mask:0xf
v_dot2c_f32_bf16_dpp v8, v22, v80 row_newbcast:8 row_mask:0xf bank_mask:0xf
v_dot2c_f32_bf16_dpp v9, v24, v80 row_newbcast:8 row_mask:0xf bank_mask:0xf
v_dot2c_f32_bf16_dpp v10, v22, v81 row_newbcast:8 row_mask:0xf bank_mask:0xf
v_dot2c_f32_bf16_dpp v11, v24, v81 row_newbcast:8 row_mask:0xf bank_mask:0xf
v_dot2c_f32_bf16_dpp v12, v22, v82 row_newbcast:8 row_mask:0xf bank_mask:0xf
v_dot2c_f32_bf16_dpp v13, v24, v82 row_newbcast:8 row_mask:0xf bank_mask:0xf
v_dot2c_f32_bf16_dpp v14, v22, v83 row_newbcast:8 row_mask:0xf bank_mask:0xf
v_dot2c_f32_bf16_dpp v15, v24, v83 row_newbcast:8 row_mask:0xf bank_mask:0xf
v_dot2c_f32_bf16_dpp v8, v22, v84 row_newbcast:9 row_mask:0xf bank_mask:0xf
v_dot2c_f32_bf16_dpp v9, v24, v84 row_newbcast:9 row_mask:0xf bank_mask:0xf
v_dot2c_f32_bf16_dpp v10, v22, v85 row_newbcast:9 row_mask:0xf bank_mask:0xf
v_dot2c_f32_bf16_dpp v11, v24, v85 row_newbcast:9 row_mask:0xf bank_mask:0xf
v_dot2c_f32_bf16_dpp v12, v22, v86 row_newbcast:9 row_mask:0xf bank_mask:0xf
v_dot2c_f32_bf16_dpp v13, v24, v86 row_newbcast:9 row_mask:0xf bank_mask:0xf
v_dot2c_f32_bf16_dpp v14, v22, v87 row_newbcast:9 row_mask:0xf bank_mask:0xf
v_dot2c_f32_bf16_dpp v15, v24, v87 row_newbcast:9 row_mask:0xf bank_mask:0xf
v_dot2c_f32_bf16_dpp v8, v22, v88 row_newbcast:10 row_mask:0xf bank_mask:0xf
v_dot2c_f32_bf16_dpp v9, v24, v88 row_newbcast:10 row_mask:0xf bank_mask:0xf
v_dot2c_f32_bf16_dpp v10, v22, v89 row_newbcast:10 row_mask:0xf bank_mask:0xf
v_dot2c_f32_bf16_dpp v11, v24, v89 row_newbcast:10 row_mask:0xf bank_mask:0xf
v_dot2c_f32_bf16_dpp v12, v22, v90 row_newbcast:10 row_mask:0xf bank_mask:0xf
v_dot2c_f32_bf16_dpp v13, v24, v90 row_newbcast:10 row_mask:0xf bank_mask:0xf
v_dot2c_f32_bf16_dpp v14, v22, v91 row_newbcast:10 row_mask:0xf bank_mask:0xf
v_dot2c_f32_bf16_dpp v15, v24, v91 row_newbcast:10 row_mask:0xf bank_mask:0xf
v_dot2c_f32_bf16_dpp v8, v22, v92 row_newbcast:11 row_mask:0xf bank_mask:0xf
v_dot2c_f32_bf16_dpp v9, v24, v92 row_newbcast:11 row_mask:0xf bank_mask:0xf
v_dot2c_f32_bf16_dpp v10, v22, v93 row_newbcast:11 row_mask:0xf bank_mask:0xf
v_dot2c_f32_bf16_dpp v11, v24, v93 row_newbcast:11 row_mask:0xf bank_mask:0xf
v_dot2c_f32_bf16_dpp v12, v22, v94 row_newbcast:11 row_mask:0xf bank_mask:0xf
v_dot2c_f32_bf16_dpp v13, v24, v94 row_newbcast:11 row_mask:0xf bank_mask:0xf
v_dot2c_f32_bf16_dpp v14, v22, v95 row_newbcast:11 row_mask:0xf bank_mask:0xf
v_dot2c_f32_bf16_dpp v15, v24, v95 row_newbcast:11 row_mask:0xf bank_mask:0xf
v_dot2c_f32_bf16_dpp v8, v22, v96 row_newbcast:12 row_mask:0xf bank_mask:0xf
v_dot2c_f32_bf16_dpp v9, v24, v96 row_newbcast:12 row_mask:0xf bank_mask:0xf
v_dot2c_f32_bf16_dpp v10, v22, v97 row_newbcast:12 row_mask:0xf bank_mask:0xf
v_dot2c_f32_bf16_dpp v11, v24, v97 row_newbcast:12 row_mask:0xf bank_mask:0xf
v_dot2c_f32_bf16_dpp v12, v22, v98 row_newbcast:12 row_mask:0xf bank_mask:0xf
v_dot2c_f32_bf16_dpp v13, v24, v98 row_newbcast:12 row_mask:0xf bank_mask:0xf
v_dot2c_f32_bf16_dpp v14, v22, v99 row_newbcast:12 row_mask:0xf bank_mask:0xf
v_dot2c_f32_bf16_dpp v15, v24, v99 row_newbcast:12 row_mask:0xf bank_mask:0xf
v_dot2c_f32_bf16_dpp v8, v22, v100 row_newbcast:13 row_mask:0xf bank_mask:0xf
v_dot2c_f32_bf16_dpp v9, v24, v100 row_newbcast:13 row_mask:0xf bank_mask:0xf
v_dot2c_f32_bf16_dpp v10, v22, v101 row_newbcast:13 row_mask:0xf bank_mask:0xf
v_dot2c_f32_bf16_dpp v11, v24, v101 row_newbcast:13 row_mask:0xf bank_mask:0xf
v_dot2c_f32_bf16_dpp v12, v22, v102 row_newbcast:13 row_mask:0xf bank_mask:0xf
v_dot2c_f32_bf16_dpp v13, v24, v102 row_newbcast:13 row_mask:0xf bank_mask:0xf
v_dot2c_f32_bf16_dpp v14, v22, v103 row_newbcast:13 row_mask:0xf bank_mask:0xf
v_dot2c_f32_bf16_dpp v15, v24, v103 row_newbcast:13 row_mask:0xf bank_mask:0xf
v_dot2c_f32_bf16_dpp v8, v22, v104 row_newbcast:14 row_mask:0xf bank_mask:0xf
v_dot2c_f32_bf16_dpp v9, v24, v104 row_newbcast:14 row_mask:0xf bank_mask:0xf
v_dot2c_f32_bf16_dpp v10, v22, v105 row_newbcast:14 row_mask:0xf bank_mask:0xf
v_dot2c_f32_bf16_dpp v11, v24, v105 row_newbcast:14 row_mask:0xf bank_mask:0xf
v_dot2c_f32_bf16_dpp v12, v22, v106 row_newbcast:14 row_mask:0xf bank_mask:0xf
v_dot2c_f32_bf16_dpp v13, v24, v106 row_newbcast:14 row_mask:0xf bank_mask:0xf
v_dot2c_f32_bf16_dpp v14, v22, v107 row_newbcast:14 row_mask:0xf bank_mask:0xf
v_dot2c_f32_bf16_dpp v15, v24, v107 row_newbcast:14 row_mask:0xf bank_mask:0xf
v_dot2c_f32_bf16_dpp v8, v22, v108 row_newbcast:15 row_mask:0xf bank_mask:0xf
v_dot2c_f32_bf16_dpp v9, v24, v108 row_newbcast:15 row_mask:0xf bank_mask:0xf
v_dot2c_f32_bf16_dpp v10, v22, v109 row_newbcast:15 row_mask:0xf bank_mask:0xf
v_dot2c_f32_bf16_dpp v11, v24, v109 row_newbcast:15 row_mask:0xf bank_mask:0xf
v_dot2c_f32_bf16_dpp v12, v22, v110 row_newbcast:15 row_mask:0xf bank_mask:0xf
v_dot2c_f32_bf16_dpp v13, v24, v110 row_newbcast:15 row_mask:0xf bank_mask:0xf
v_dot2c_f32_bf16_dpp v14, v22, v111 row_newbcast:15 row_mask:0xf bank_mask:0xf
v_dot2c_f32_bf16_dpp v15, v24, v111 row_newbcast:15 row_mask:0xf bank_mask:0xf
s_waitcnt vmcnt(1)
v_dot2c_f32_bf16_dpp v8, v23, v180 row_newbcast:0 row_mask:0xf bank_mask:0xf
v_dot2c_f32_bf16_dpp v9, v25, v180 row_newbcast:0 row_mask:0xf bank_mask:0xf
v_dot2c_f32_bf16_dpp v10, v23, v181 row_newbcast:0 row_mask:0xf bank_mask:0xf
v_dot2c_f32_bf16_dpp v11, v25, v181 row_newbcast:0 row_mask:0xf bank_mask:0xf
v_dot2c_f32_bf16_dpp v12, v23, v182 row_newbcast:0 row_mask:0xf bank_mask:0xf
v_dot2c_f32_bf16_dpp v13, v25, v182 row_newbcast:0 row_mask:0xf bank_mask:0xf
v_dot2c_f32_bf16_dpp v14, v23, v183 row_newbcast:0 row_mask:0xf bank_mask:0xf
v_dot2c_f32_bf16_dpp v15, v25, v183 row_newbcast:0 row_mask:0xf bank_mask:0xf
v_dot2c_f32_bf16_dpp v8, v23, v184 row_newbcast:1 row_mask:0xf bank_mask:0xf
v_dot2c_f32_bf16_dpp v9, v25, v184 row_newbcast:1 row_mask:0xf bank_mask:0xf
v_dot2c_f32_bf16_dpp v10, v23, v185 row_newbcast:1 row_mask:0xf bank_mask:0xf
v_dot2c_f32_bf16_dpp v11, v25, v185 row_newbcast:1 row_mask:0xf bank_mask:0xf
v_dot2c_f32_bf16_dpp v12, v23, v186 row_newbcast:1 row_mask:0xf bank_mask:0xf
v_dot2c_f32_bf16_dpp v13, v25, v186 row_newbcast:1 row_mask:0xf bank_mask:0xf
v_dot2c_f32_bf16_dpp v14, v23, v187 row_newbcast:1 row_mask:0xf bank_mask:0xf
v_dot2c_f32_bf16_dpp v15, v25, v187 row_newbcast:1 row_mask:0xf bank_mask:0xf
v_dot2c_f32_bf16_dpp v8, v23, v188 row_newbcast:2 row_mask:0xf bank_mask:0xf
v_dot2c_f32_bf16_dpp v9, v25, v188 row_newbcast:2 row_mask:0xf bank_mask:0xf
v_dot2c_f32_bf16_dpp v10, v23, v189 row_newbcast:2 row_mask:0xf bank_mask:0xf
v_dot2c_f32_bf16_dpp v11, v25, v189 row_newbcast:2 row_mask:0xf bank_mask:0xf
v_dot2c_f32_bf16_dpp v12, v23, v190 row_newbcast:2 row_mask:0xf bank_mask:0xf
v_dot2c_f32_bf16_dpp v13, v25, v190 row_newbcast:2 row_mask:0xf bank_mask:0xf
v_dot2c_f32_bf16_dpp v14, v23, v191 row_newbcast:2 row_mask:0xf bank_mask:0xf
v_dot2c_f32_bf16_dpp v15, v25, v191 row_newbcast:2 row_mask:0xf bank_mask:0xf
v_dot2c_f32_bf16_dpp v8, v23, v192 row_newbcast:3 row_mask:0xf bank_mask:0xf
v_dot2c_f32_bf16_dpp v9, v25, v192 row_newbcast:3 row_mask:0xf bank_mask:0xf
v_dot2c_f32_bf16_dpp v10, v23, v193 row_newbcast:3 row_mask:0xf bank_mask:0xf
v_dot2c_f32_bf16_dpp v11, v25, v193 row_newbcast:3 row_mask:0xf bank_mask:0xf
v_dot2c_f32_bf16_dpp v12, v23, v194 row_newbcast:3 row_mask:0xf bank_mask:0xf
v_dot2c_f32_bf16_dpp v13, v25, v194 row_newbcast:3 row_mask:0xf bank_mask:0xf
v_dot2c_f32_bf16_dpp v14, v23, v195 row_newbcast:3 row_mask:0xf bank_mask:0xf
v_dot2c_f32_bf16_dpp v15, v25, v195 row_newbcast:3 row_mask:0xf bank_mask:0xf
v_dot2c_f32_bf16_dpp v8, v23, v196 row_newbcast:4 row_mask:0xf bank_mask:0xf
v_dot2c_f32_bf16_dpp v9, v25, v196 row_newbcast:4 row_mask:0xf bank_mask:0xf
v_dot2c_f32_bf16_dpp v10, v23, v197 row_newbcast:4 row_mask:0xf bank_mask:0xf
v_dot2c_f32_bf16_dpp v11, v25, v197 row_newbcast:4 row_mask:0xf bank_mask:0xf
v_dot2c_f32_bf16_dpp v12, v23, v198 row_newbcast:4 row_mask:0xf bank_mask:0xf
v_dot2c_f32_bf16_dpp v13, v25, v198 row_newbcast:4 row_mask:0xf bank_mask:0xf
v_dot2c_f32_bf16_dpp v14, v23, v199 row_newbcast:4 row_mask:0xf bank_mask:0xf
v_dot2c_f32_bf16_dpp v15, v25, v199 row_newbcast:4 row_mask:0xf bank_mask:0xf
v_dot2c_f32_bf16_dpp v8, v23, v200 row_newbcast:5 row_mask:0xf bank_mask:0xf
v_dot2c_f32_bf16_dpp v9, v25, v200 row_newbcast:5 row_mask:0xf bank_mask:0xf
v_dot2c_f32_bf16_dpp v10, v23, v201 row_newbcast:5 row_mask:0xf bank_mask:0xf
v_dot2c_f32_bf16_dpp v11, v25, v201 row_newbcast:5 row_mask:0xf bank_mask:0xf
v_dot2c_f32_bf16_dpp v12, v23, v202 row_newbcast:5 row_mask:0xf bank_mask:0xf
v_dot2c_f32_bf16_dpp v13, v25, v202 row_newbcast:5 row_mask:0xf bank_mask:0xf
v_dot2c_f32_bf16_dpp v14, v23, v203 row_newbcast:5 row_mask:0xf bank_mask:0xf
v_dot2c_f32_bf16_dpp v15, v25, v203 row_newbcast:5 row_mask:0xf bank_mask:0xf
v_dot2c_f32_bf16_dpp v8, v23, v204 row_newbcast:6 row_mask:0xf bank_mask:0xf
v_dot2c_f32_bf16_dpp v9, v25, v204 row_newbcast:6 row_mask:0xf bank_mask:0xf
v_dot2c_f32_bf16_dpp v10, v23, v205 row_newbcast:6 row_mask:0xf bank_mask:0xf
v_dot2c_f32_bf16_dpp v11, v25, v205 row_newbcast:6 row_mask:0xf bank_mask:0xf
v_dot2c_f32_bf16_dpp v12, v23, v206 row_newbcast:6 row_mask:0xf bank_mask:0xf
v_dot2c_f32_bf16_dpp v13, v25, v206 row_newbcast:6 row_mask:0xf bank_mask:0xf
v_dot2c_f32_bf16_dpp v14, v23, v207 row_newbcast:6 row_mask:0xf bank_mask:0xf
v_dot2c_f32_bf16_dpp v15, v25, v207 row_newbcast:6 row_mask:0xf bank_mask:0xf
v_dot2c_f32_bf16_dpp v8, v23, v208 row_newbcast:7 row_mask:0xf bank_mask:0xf
v_dot2c_f32_bf16_dpp v9, v25, v208 row_newbcast:7 row_mask:0xf bank_mask:0xf
v_dot2c_f32_bf16_dpp v10, v23, v209 row_newbcast:7 row_mask:0xf bank_mask:0xf
v_dot2c_f32_bf16_dpp v11, v25, v209 row_newbcast:7 row_mask:0xf bank_mask:0xf
v_dot2c_f32_bf16_dpp v12, v23, v210 row_newbcast:7 row_mask:0xf bank_mask:0xf
v_dot2c_f32_bf16_dpp v13, v25, v210 row_newbcast:7 row_mask:0xf bank_mask:0xf
v_dot2c_f32_bf16_dpp v14, v23, v211 row_newbcast:7 row_mask:0xf bank_mask:0xf
v_dot2c_f32_bf16_dpp v15, v25, v211 row_newbcast:7 row_mask:0xf bank_mask:0xf
v_dot2c_f32_bf16_dpp v8, v23, v212 row_newbcast:8 row_mask:0xf bank_mask:0xf
v_dot2c_f32_bf16_dpp v9, v25, v212 row_newbcast:8 row_mask:0xf bank_mask:0xf
v_dot2c_f32_bf16_dpp v10, v23, v213 row_newbcast:8 row_mask:0xf bank_mask:0xf
v_dot2c_f32_bf16_dpp v11, v25, v213 row_newbcast:8 row_mask:0xf bank_mask:0xf
v_dot2c_f32_bf16_dpp v12, v23, v214 row_newbcast:8 row_mask:0xf bank_mask:0xf
v_dot2c_f32_bf16_dpp v13, v25, v214 row_newbcast:8 row_mask:0xf bank_mask:0xf
v_dot2c_f32_bf16_dpp v14, v23, v215 row_newbcast:8 row_mask:0xf bank_mask:0xf
v_dot2c_f32_bf16_dpp v15, v25, v215 row_newbcast:8 row_mask:0xf bank_mask:0xf
v_dot2c_f32_bf16_dpp v8, v23, v216 row_newbcast:9 row_mask:0xf bank_mask:0xf
v_dot2c_f32_bf16_dpp v9, v25, v216 row_newbcast:9 row_mask:0xf bank_mask:0xf
v_dot2c_f32_bf16_dpp v10, v23, v217 row_newbcast:9 row_mask:0xf bank_mask:0xf
v_dot2c_f32_bf16_dpp v11, v25, v217 row_newbcast:9 row_mask:0xf bank_mask:0xf
v_dot2c_f32_bf16_dpp v12, v23, v218 row_newbcast:9 row_mask:0xf bank_mask:0xf
v_dot2c_f32_bf16_dpp v13, v25, v218 row_newbcast:9 row_mask:0xf bank_mask:0xf
v_dot2c_f32_bf16_dpp v14, v23, v219 row_newbcast:9 row_mask:0xf bank_mask:0xf
v_dot2c_f32_bf16_dpp v15, v25, v219 row_newbcast:9 row_mask:0xf bank_mask:0xf
v_dot2c_f32_bf16_dpp v8, v23, v220 row_newbcast:10 row_mask:0xf bank_mask:0xf
v_dot2c_f32_bf16_dpp v9, v25, v220 row_newbcast:10 row_mask:0xf bank_mask:0xf
v_dot2c_f32_bf16_dpp v10, v23, v221 row_newbcast:10 row_mask:0xf bank_mask:0xf
v_dot2c_f32_bf16_dpp v11, v25, v221 row_newbcast:10 row_mask:0xf bank_mask:0xf
v_dot2c_f32_bf16_dpp v12, v23, v222 row_newbcast:10 row_mask:0xf bank_mask:0xf
v_dot2c_f32_bf16_dpp v13, v25, v222 row_newbcast:10 row_mask:0xf bank_mask:0xf
v_dot2c_f32_bf16_dpp v14, v23, v223 row_newbcast:10 row_mask:0xf bank_mask:0xf
v_dot2c_f32_bf16_dpp v15, v25, v223 row_newbcast:10 row_mask:0xf bank_mask:0xf
v_dot2c_f32_bf16_dpp v8, v23, v224 row_newbcast:11 row_mask:0xf bank_mask:0xf
v_dot2c_f32_bf16_dpp v9, v25, v224 row_newbcast:11 row_mask:0xf bank_mask:0xf
v_dot2c_f32_bf16_dpp v10, v23, v225 row_newbcast:11 row_mask:0xf bank_mask:0xf
v_dot2c_f32_bf16_dpp v11, v25, v225 row_newbcast:11 row_mask:0xf bank_mask:0xf
v_dot2c_f32_bf16_dpp v12, v23, v226 row_newbcast:11 row_mask:0xf bank_mask:0xf
v_dot2c_f32_bf16_dpp v13, v25, v226 row_newbcast:11 row_mask:0xf bank_mask:0xf
v_dot2c_f32_bf16_dpp v14, v23, v227 row_newbcast:11 row_mask:0xf bank_mask:0xf
v_dot2c_f32_bf16_dpp v15, v25, v227 row_newbcast:11 row_mask:0xf bank_mask:0xf
v_dot2c_f32_bf16_dpp v8, v23, v228 row_newbcast:12 row_mask:0xf bank_mask:0xf
v_dot2c_f32_bf16_dpp v9, v25, v228 row_newbcast:12 row_mask:0xf bank_mask:0xf
v_dot2c_f32_bf16_dpp v10, v23, v229 row_newbcast:12 row_mask:0xf bank_mask:0xf
v_dot2c_f32_bf16_dpp v11, v25, v229 row_newbcast:12 row_mask:0xf bank_mask:0xf
v_dot2c_f32_bf16_dpp v12, v23, v230 row_newbcast:12 row_mask:0xf bank_mask:0xf
v_dot2c_f32_bf16_dpp v13, v25, v230 row_newbcast:12 row_mask:0xf bank_mask:0xf
v_dot2c_f32_bf16_dpp v14, v23, v231 row_newbcast:12 row_mask:0xf bank_mask:0xf
v_dot2c_f32_bf16_dpp v15, v25, v231 row_newbcast:12 row_mask:0xf bank_mask:0xf
v_dot2c_f32_bf16_dpp v8, v23, v232 row_newbcast:13 row_mask:0xf bank_mask:0xf
v_dot2c_f32_bf16_dpp v9, v25, v232 row_newbcast:13 row_mask:0xf bank_mask:0xf
v_dot2c_f32_bf16_dpp v10, v23, v233 row_newbcast:13 row_mask:0xf bank_mask:0xf
v_dot2c_f32_bf16_dpp v11, v25, v233 row_newbcast:13 row_mask:0xf bank_mask:0xf
v_dot2c_f32_bf16_dpp v12, v23, v234 row_newbcast:13 row_mask:0xf bank_mask:0xf
v_dot2c_f32_bf16_dpp v13, v25, v234 row_newbcast:13 row_mask:0xf bank_mask:0xf
v_dot2c_f32_bf16_dpp v14, v23, v235 row_newbcast:13 row_mask:0xf bank_mask:0xf
v_dot2c_f32_bf16_dpp v15, v25, v235 row_newbcast:13 row_mask:0xf bank_mask:0xf
v_dot2c_f32_bf16_dpp v8, v23, v236 row_newbcast:14 row_mask:0xf bank_mask:0xf
v_dot2c_f32_bf16_dpp v9, v25, v236 row_newbcast:14 row_mask:0xf bank_mask:0xf
v_dot2c_f32_bf16_dpp v10, v23, v237 row_newbcast:14 row_mask:0xf bank_mask:0xf
v_dot2c_f32_bf16_dpp v11, v25, v237 row_newbcast:14 row_mask:0xf bank_mask:0xf
v_dot2c_f32_bf16_dpp v12, v23, v238 row_newbcast:14 row_mask:0xf bank_mask:0xf
v_dot2c_f32_bf16_dpp v13, v25, v238 row_newbcast:14 row_mask:0xf bank_mask:0xf
v_dot2c_f32_bf16_dpp v14, v23, v239 row_newbcast:14 row_mask:0xf bank_mask:0xf
v_dot2c_f32_bf16_dpp v15, v25, v239 row_newbcast:14 row_mask:0xf bank_mask:0xf
v_dot2c_f32_bf16_dpp v8, v23, v240 row_newbcast:15 row_mask:0xf bank_mask:0xf
v_dot2c_f32_bf16_dpp v9, v25, v240 row_newbcast:15 row_mask:0xf bank_mask:0xf
v_dot2c_f32_bf16_dpp v10, v23, v241 row_newbcast:15 row_mask:0xf bank_mask:0xf
v_dot2c_f32_bf16_dpp v11, v25, v241 row_newbcast:15 row_mask:0xf bank_mask:0xf
v_dot2c_f32_bf16_dpp v12, v23, v242 row_newbcast:15 row_mask:0xf bank_mask:0xf
v_dot2c_f32_bf16_dpp v13, v25, v242 row_newbcast:15 row_mask:0xf bank_mask:0xf
v_dot2c_f32_bf16_dpp v14, v23, v243 row_newbcast:15 row_mask:0xf bank_mask:0xf
v_dot2c_f32_bf16_dpp v15, v25, v243 row_newbcast:15 row_mask:0xf bank_mask:0xf
v_permlane32_swap_b32 v8, v12
v_permlane32_swap_b32 v9, v13
v_permlane32_swap_b32 v10, v14
v_permlane32_swap_b32 v11, v15
v_add_f32 v8, v8, v12
v_add_f32 v9, v9, v13
v_add_f32 v10, v10, v14
v_add_f32 v11, v11, v15
s_nop 0
v_permlane16_swap_b32 v8, v10
v_permlane16_swap_b32 v9, v11
v_add_f32 v8, v8, v10
v_add_f32 v9, v9, v11
s_lshl_b32 s59, s48, 9
v_add_u32 v37, s59, v20
ds_write_b64 v37, v[8:9] offset:2048
v_mov_b32 v38, 0
v_mov_b32 v39, 1
s_waitcnt lgkmcnt(0)
s_mov_b64 exec, 1
ds_add_u32 v38, v39 offset:9604
s_mov_b64 exec, -1
s_mov_b32 s58, 0
buffer_load_dwordx4 v[148:151], v2, s[24:27], s58 offen offset:0 nt
buffer_load_dwordx4 v[152:155], v2, s[24:27], s58 offen offset:1024 nt
buffer_load_dwordx4 v[156:159], v2, s[24:27], s58 offen offset:2048 nt
buffer_load_dwordx4 v[160:163], v2, s[24:27], s58 offen offset:3072 nt
s_mov_b32 s58, 0
buffer_load_dwordx4 v[164:167], v2, s[28:31], s58 offen offset:0 nt
buffer_load_dwordx4 v[168:171], v2, s[28:31], s58 offen offset:1024 nt
buffer_load_dwordx4 v[172:175], v2, s[28:31], s58 offen offset:2048 nt
buffer_load_dwordx4 v[176:179], v2, s[28:31], s58 offen offset:3072 nt
s_mov_b32 s58, 65536
buffer_load_dwordx4 v[180:183], v2, s[24:27], s58 offen offset:0 nt
buffer_load_dwordx4 v[184:187], v2, s[24:27], s58 offen offset:1024 nt
buffer_load_dwordx4 v[188:191], v2, s[24:27], s58 offen offset:2048 nt
buffer_load_dwordx4 v[192:195], v2, s[24:27], s58 offen offset:3072 nt
s_mov_b32 s58, 65536
buffer_load_dwordx4 v[196:199], v2, s[28:31], s58 offen offset:0 nt
buffer_load_dwordx4 v[200:203], v2, s[28:31], s58 offen offset:1024 nt
buffer_load_dwordx4 v[204:207], v2, s[28:31], s58 offen offset:2048 nt
buffer_load_dwordx4 v[208:211], v2, s[28:31], s58 offen offset:3072 nt
s_mov_b32 s58, 131072
buffer_load_dwordx4 v[212:215], v2, s[24:27], s58 offen offset:0 nt
buffer_load_dwordx4 v[216:219], v2, s[24:27], s58 offen offset:1024 nt
buffer_load_dwordx4 v[220:223], v2, s[24:27], s58 offen offset:2048 nt
buffer_load_dwordx4 v[224:227], v2, s[24:27], s58 offen offset:3072 nt
s_mov_b32 s58, 131072
buffer_load_dwordx4 v[228:231], v2, s[28:31], s58 offen offset:0 nt
buffer_load_dwordx4 v[232:235], v2, s[28:31], s58 offen offset:1024 nt
buffer_load_dwordx4 v[236:239], v2, s[28:31], s58 offen offset:2048 nt
buffer_load_dwordx4 v[240:243], v2, s[28:31], s58 offen offset:3072 nt
v_mov_b32 v38, 0
L_fl_2:
ds_read_b32 v39, v38 offset:9604
s_waitcnt lgkmcnt(0)
v_readfirstlane_b32 s59, v39
s_cmp_ge_u32 s59, 4
s_cbranch_scc1 L_fl_2_ok
s_branch L_fl_2
L_fl_2_ok:
ds_read_b64 v[40:41], v20 offset:2048
ds_read_b64 v[42:43], v20 offset:2560
ds_read_b64 v[44:45], v20 offset:3072
ds_read_b64 v[46:47], v20 offset:3584
s_waitcnt lgkmcnt(0)
v_pk_add_f32 v[40:41], v[40:41], v[42:43]
v_pk_add_f32 v[44:45], v[44:45], v[46:47]
v_pk_add_f32 v[40:41], v[40:41], v[44:45]
v_cvt_pk_bf16_f32 v4, v40, v41
v_mov_b32 v5, v4
s_nop 1
v_permlane16_swap_b32 v4, v5
v_mov_b32 v6, v4
v_mov_b32 v7, v5
s_nop 0
v_permlane32_swap_b32 v4, v6
v_permlane32_swap_b32 v5, v7
v_mov_b32 v8, 0
v_mov_b32 v9, 0
v_mov_b32 v10, 0
v_mov_b32 v11, 0
v_mov_b32 v12, 0
v_mov_b32 v13, 0
v_mov_b32 v14, 0
v_mov_b32 v15, 0
v_mov_b32 v16, 0xff7fffff
v_mov_b32 v17, 0
s_mul_i32 s63, s64, 0x9e3779b1
s_add_u32 s63, s63, 0x7f4a7c15
s_waitcnt vmcnt(20)
v_dot2_f32_bf16 v22, v148, v4, 0
v_dot2_f32_bf16 v23, v152, v4, 0
v_dot2_f32_bf16 v24, v156, v4, 0
v_dot2_f32_bf16 v25, v160, v4, 0
v_dot2c_f32_bf16 v22, v149, v5
v_dot2c_f32_bf16 v23, v153, v5
v_dot2c_f32_bf16 v24, v157, v5
v_dot2c_f32_bf16 v25, v161, v5
v_dot2c_f32_bf16 v22, v150, v6
v_dot2c_f32_bf16 v23, v154, v6
v_dot2c_f32_bf16 v24, v158, v6
v_dot2c_f32_bf16 v25, v162, v6
v_dot2c_f32_bf16 v22, v151, v7
v_dot2c_f32_bf16 v23, v155, v7
v_dot2c_f32_bf16 v24, v159, v7
v_dot2c_f32_bf16 v25, v163, v7
s_mov_b32 s58, 196608
buffer_load_dwordx4 v[148:151], v2, s[24:27], s58 offen offset:0 nt
buffer_load_dwordx4 v[152:155], v2, s[24:27], s58 offen offset:1024 nt
buffer_load_dwordx4 v[156:159], v2, s[24:27], s58 offen offset:2048 nt
buffer_load_dwordx4 v[160:163], v2, s[24:27], s58 offen offset:3072 nt
v_add_f32_dpp v26, v22, v22 row_ror:8 row_mask:0xf bank_mask:0x3
v_add_f32_dpp v27, v23, v23 row_ror:8 row_mask:0xf bank_mask:0x3
s_nop 0
v_add_f32_dpp v26, v24, v24 row_ror:8 row_mask:0xf bank_mask:0xc
v_add_f32_dpp v27, v25, v25 row_ror:8 row_mask:0xf bank_mask:0xc
s_nop 0
v_add_f32_dpp v28, v26, v26 row_half_mirror row_mask:0xf bank_mask:0x5
s_nop 1
v_add_f32_dpp v28, v27, v27 row_half_mirror row_mask:0xf bank_mask:0xa
s_nop 1
v_add_f32_dpp v28, v28, v28 quad_perm:[1,0,3,2] row_mask:0xf bank_mask:0xf
s_nop 1
v_add_f32_dpp v28, v28, v28 quad_perm:[2,3,0,1] row_mask:0xf bank_mask:0xf
v_cvt_pk_bf16_f32 v28, v28, v28
v_and_b32 v28, s62, v28
v_mul_f32 v28, s60, v28
v_cvt_pk_bf16_f32 v28, v28, v28
v_and_b32 v28, s62, v28
s_nop 1
v_max_f32_dpp v29, v28, v28 row_ror:8 row_mask:0xf bank_mask:0xf
s_nop 1
v_max_f32_dpp v29, v29, v29 row_ror:4 row_mask:0xf bank_mask:0xf
v_max_f32 v29, v29, v16
v_sub_f32 v30, v16, v29
v_sub_f32 v31, v28, v29
v_mov_b32 v16, v29
v_mul_f32 v30, s61, v30
v_mul_f32 v31, s61, v31
v_exp_f32 v30, v30
v_exp_f32 v31, v31
s_nop 0
v_fma_f32 v17, v17, v30, v31
v_cvt_pk_bf16_f32 v32, v31, 0
v_cvt_pk_bf16_f32 v33, 0, v31
v_mul_f32 v8, v8, v30
v_mul_f32 v9, v9, v30
v_mul_f32 v10, v10, v30
v_mul_f32 v11, v11, v30
v_mul_f32 v12, v12, v30
v_mul_f32 v13, v13, v30
v_mul_f32 v14, v14, v30
v_mul_f32 v15, v15, v30
s_waitcnt vmcnt(20)
v_dot2c_f32_bf16_dpp v8, v32, v164 row_newbcast:0 row_mask:0xf bank_mask:0xf
v_dot2c_f32_bf16_dpp v9, v33, v164 row_newbcast:0 row_mask:0xf bank_mask:0xf
v_dot2c_f32_bf16_dpp v10, v32, v165 row_newbcast:0 row_mask:0xf bank_mask:0xf
v_dot2c_f32_bf16_dpp v11, v33, v165 row_newbcast:0 row_mask:0xf bank_mask:0xf
v_dot2c_f32_bf16_dpp v12, v32, v166 row_newbcast:0 row_mask:0xf bank_mask:0xf
v_dot2c_f32_bf16_dpp v13, v33, v166 row_newbcast:0 row_mask:0xf bank_mask:0xf
v_dot2c_f32_bf16_dpp v14, v32, v167 row_newbcast:0 row_mask:0xf bank_mask:0xf
v_dot2c_f32_bf16_dpp v15, v33, v167 row_newbcast:0 row_mask:0xf bank_mask:0xf
v_dot2c_f32_bf16_dpp v8, v32, v168 row_newbcast:4 row_mask:0xf bank_mask:0xf
v_dot2c_f32_bf16_dpp v9, v33, v168 row_newbcast:4 row_mask:0xf bank_mask:0xf
v_dot2c_f32_bf16_dpp v10, v32, v169 row_newbcast:4 row_mask:0xf bank_mask:0xf
v_dot2c_f32_bf16_dpp v11, v33, v169 row_newbcast:4 row_mask:0xf bank_mask:0xf
v_dot2c_f32_bf16_dpp v12, v32, v170 row_newbcast:4 row_mask:0xf bank_mask:0xf
v_dot2c_f32_bf16_dpp v13, v33, v170 row_newbcast:4 row_mask:0xf bank_mask:0xf
v_dot2c_f32_bf16_dpp v14, v32, v171 row_newbcast:4 row_mask:0xf bank_mask:0xf
v_dot2c_f32_bf16_dpp v15, v33, v171 row_newbcast:4 row_mask:0xf bank_mask:0xf
v_dot2c_f32_bf16_dpp v8, v32, v172 row_newbcast:8 row_mask:0xf bank_mask:0xf
v_dot2c_f32_bf16_dpp v9, v33, v172 row_newbcast:8 row_mask:0xf bank_mask:0xf
v_dot2c_f32_bf16_dpp v10, v32, v173 row_newbcast:8 row_mask:0xf bank_mask:0xf
v_dot2c_f32_bf16_dpp v11, v33, v173 row_newbcast:8 row_mask:0xf bank_mask:0xf
v_dot2c_f32_bf16_dpp v12, v32, v174 row_newbcast:8 row_mask:0xf bank_mask:0xf
v_dot2c_f32_bf16_dpp v13, v33, v174 row_newbcast:8 row_mask:0xf bank_mask:0xf
v_dot2c_f32_bf16_dpp v14, v32, v175 row_newbcast:8 row_mask:0xf bank_mask:0xf
v_dot2c_f32_bf16_dpp v15, v33, v175 row_newbcast:8 row_mask:0xf bank_mask:0xf
v_dot2c_f32_bf16_dpp v8, v32, v176 row_newbcast:12 row_mask:0xf bank_mask:0xf
v_dot2c_f32_bf16_dpp v9, v33, v176 row_newbcast:12 row_mask:0xf bank_mask:0xf
v_dot2c_f32_bf16_dpp v10, v32, v177 row_newbcast:12 row_mask:0xf bank_mask:0xf
v_dot2c_f32_bf16_dpp v11, v33, v177 row_newbcast:12 row_mask:0xf bank_mask:0xf
v_dot2c_f32_bf16_dpp v12, v32, v178 row_newbcast:12 row_mask:0xf bank_mask:0xf
v_dot2c_f32_bf16_dpp v13, v33, v178 row_newbcast:12 row_mask:0xf bank_mask:0xf
v_dot2c_f32_bf16_dpp v14, v32, v179 row_newbcast:12 row_mask:0xf bank_mask:0xf
v_dot2c_f32_bf16_dpp v15, v33, v179 row_newbcast:12 row_mask:0xf bank_mask:0xf
s_mov_b32 s58, 196608
buffer_load_dwordx4 v[164:167], v2, s[28:31], s58 offen offset:0 nt
buffer_load_dwordx4 v[168:171], v2, s[28:31], s58 offen offset:1024 nt
buffer_load_dwordx4 v[172:175], v2, s[28:31], s58 offen offset:2048 nt
buffer_load_dwordx4 v[176:179], v2, s[28:31], s58 offen offset:3072 nt
v_mov_b32 v22, 0
L_fl_3:
ds_read_b32 v23, v22 offset:9620
s_waitcnt lgkmcnt(0)
v_readfirstlane_b32 s59, v23
s_cmp_ge_u32 s59, 1
s_cbranch_scc1 L_fl_3_ok
s_sleep 1
s_branch L_fl_3
L_fl_3_ok:
ds_read_b32 v23, v22 offset:9616
s_waitcnt lgkmcnt(0)
v_readfirstlane_b32 s65, v23
s_and_b32 s59, s49, 1
s_cmp_lg_u32 s59, s65
s_cselect_b32 s42, 0, s42
s_cselect_b32 s46, 0, s46
s_mov_b32 s58, 0
buffer_load_dwordx4 v[48:51], v113, s[40:43], s58 offen
s_mov_b32 s58, 28672
buffer_load_dwordx4 v[52:55], v113, s[40:43], s58 offen
s_mov_b32 s58, 57344
buffer_load_dwordx4 v[56:59], v113, s[40:43], s58 offen
s_mov_b32 s58, 86016
buffer_load_dwordx4 v[60:63], v113, s[40:43], s58 offen
s_mov_b32 s58, 114688
buffer_load_dwordx4 v[64:67], v113, s[40:43], s58 offen
s_mov_b32 s58, 143360
buffer_load_dwordx4 v[68:71], v113, s[40:43], s58 offen
s_mov_b32 s58, 172032
buffer_load_dwordx4 v[72:75], v113, s[40:43], s58 offen
s_mov_b32 s58, 200704
buffer_load_dwordx4 v[76:79], v113, s[40:43], s58 offen
s_waitcnt vmcnt(28)
v_dot2_f32_bf16 v22, v180, v4, 0
v_dot2_f32_bf16 v23, v184, v4, 0
v_dot2_f32_bf16 v24, v188, v4, 0
v_dot2_f32_bf16 v25, v192, v4, 0
v_dot2c_f32_bf16 v22, v181, v5
v_dot2c_f32_bf16 v23, v185, v5
v_dot2c_f32_bf16 v24, v189, v5
v_dot2c_f32_bf16 v25, v193, v5
v_dot2c_f32_bf16 v22, v182, v6
v_dot2c_f32_bf16 v23, v186, v6
v_dot2c_f32_bf16 v24, v190, v6
v_dot2c_f32_bf16 v25, v194, v6
v_dot2c_f32_bf16 v22, v183, v7
v_dot2c_f32_bf16 v23, v187, v7
v_dot2c_f32_bf16 v24, v191, v7
v_dot2c_f32_bf16 v25, v195, v7
s_mov_b32 s58, 262144
buffer_load_dwordx4 v[180:183], v2, s[24:27], s58 offen offset:0 nt
buffer_load_dwordx4 v[184:187], v2, s[24:27], s58 offen offset:1024 nt
buffer_load_dwordx4 v[188:191], v2, s[24:27], s58 offen offset:2048 nt
buffer_load_dwordx4 v[192:195], v2, s[24:27], s58 offen offset:3072 nt
v_add_f32_dpp v26, v22, v22 row_ror:8 row_mask:0xf bank_mask:0x3
v_add_f32_dpp v27, v23, v23 row_ror:8 row_mask:0xf bank_mask:0x3
s_nop 0
v_add_f32_dpp v26, v24, v24 row_ror:8 row_mask:0xf bank_mask:0xc
v_add_f32_dpp v27, v25, v25 row_ror:8 row_mask:0xf bank_mask:0xc
s_nop 0
v_add_f32_dpp v28, v26, v26 row_half_mirror row_mask:0xf bank_mask:0x5
s_nop 1
v_add_f32_dpp v28, v27, v27 row_half_mirror row_mask:0xf bank_mask:0xa
s_nop 1
v_add_f32_dpp v28, v28, v28 quad_perm:[1,0,3,2] row_mask:0xf bank_mask:0xf
s_nop 1
v_add_f32_dpp v28, v28, v28 quad_perm:[2,3,0,1] row_mask:0xf bank_mask:0xf
v_cvt_pk_bf16_f32 v28, v28, v28
v_and_b32 v28, s62, v28
v_mul_f32 v28, s60, v28
v_cvt_pk_bf16_f32 v28, v28, v28
v_and_b32 v28, s62, v28
s_nop 1
v_max_f32_dpp v29, v28, v28 row_ror:8 row_mask:0xf bank_mask:0xf
s_nop 1
v_max_f32_dpp v29, v29, v29 row_ror:4 row_mask:0xf bank_mask:0xf
v_max_f32 v29, v29, v16
v_sub_f32 v30, v16, v29
v_sub_f32 v31, v28, v29
v_mov_b32 v16, v29
v_mul_f32 v30, s61, v30
v_mul_f32 v31, s61, v31
v_exp_f32 v30, v30
v_exp_f32 v31, v31
s_nop 0
v_fma_f32 v17, v17, v30, v31
v_cvt_pk_bf16_f32 v32, v31, 0
v_cvt_pk_bf16_f32 v33, 0, v31
v_mul_f32 v8, v8, v30
v_mul_f32 v9, v9, v30
v_mul_f32 v10, v10, v30
v_mul_f32 v11, v11, v30
v_mul_f32 v12, v12, v30
v_mul_f32 v13, v13, v30
v_mul_f32 v14, v14, v30
v_mul_f32 v15, v15, v30
s_waitcnt vmcnt(28)
v_dot2c_f32_bf16_dpp v8, v32, v196 row_newbcast:0 row_mask:0xf bank_mask:0xf
v_dot2c_f32_bf16_dpp v9, v33, v196 row_newbcast:0 row_mask:0xf bank_mask:0xf
v_dot2c_f32_bf16_dpp v10, v32, v197 row_newbcast:0 row_mask:0xf bank_mask:0xf
v_dot2c_f32_bf16_dpp v11, v33, v197 row_newbcast:0 row_mask:0xf bank_mask:0xf
v_dot2c_f32_bf16_dpp v12, v32, v198 row_newbcast:0 row_mask:0xf bank_mask:0xf
v_dot2c_f32_bf16_dpp v13, v33, v198 row_newbcast:0 row_mask:0xf bank_mask:0xf
v_dot2c_f32_bf16_dpp v14, v32, v199 row_newbcast:0 row_mask:0xf bank_mask:0xf
v_dot2c_f32_bf16_dpp v15, v33, v199 row_newbcast:0 row_mask:0xf bank_mask:0xf
v_dot2c_f32_bf16_dpp v8, v32, v200 row_newbcast:4 row_mask:0xf bank_mask:0xf
v_dot2c_f32_bf16_dpp v9, v33, v200 row_newbcast:4 row_mask:0xf bank_mask:0xf
v_dot2c_f32_bf16_dpp v10, v32, v201 row_newbcast:4 row_mask:0xf bank_mask:0xf
v_dot2c_f32_bf16_dpp v11, v33, v201 row_newbcast:4 row_mask:0xf bank_mask:0xf
v_dot2c_f32_bf16_dpp v12, v32, v202 row_newbcast:4 row_mask:0xf bank_mask:0xf
v_dot2c_f32_bf16_dpp v13, v33, v202 row_newbcast:4 row_mask:0xf bank_mask:0xf
v_dot2c_f32_bf16_dpp v14, v32, v203 row_newbcast:4 row_mask:0xf bank_mask:0xf
v_dot2c_f32_bf16_dpp v15, v33, v203 row_newbcast:4 row_mask:0xf bank_mask:0xf
v_dot2c_f32_bf16_dpp v8, v32, v204 row_newbcast:8 row_mask:0xf bank_mask:0xf
v_dot2c_f32_bf16_dpp v9, v33, v204 row_newbcast:8 row_mask:0xf bank_mask:0xf
v_dot2c_f32_bf16_dpp v10, v32, v205 row_newbcast:8 row_mask:0xf bank_mask:0xf
v_dot2c_f32_bf16_dpp v11, v33, v205 row_newbcast:8 row_mask:0xf bank_mask:0xf
v_dot2c_f32_bf16_dpp v12, v32, v206 row_newbcast:8 row_mask:0xf bank_mask:0xf
v_dot2c_f32_bf16_dpp v13, v33, v206 row_newbcast:8 row_mask:0xf bank_mask:0xf
v_dot2c_f32_bf16_dpp v14, v32, v207 row_newbcast:8 row_mask:0xf bank_mask:0xf
v_dot2c_f32_bf16_dpp v15, v33, v207 row_newbcast:8 row_mask:0xf bank_mask:0xf
v_dot2c_f32_bf16_dpp v8, v32, v208 row_newbcast:12 row_mask:0xf bank_mask:0xf
v_dot2c_f32_bf16_dpp v9, v33, v208 row_newbcast:12 row_mask:0xf bank_mask:0xf
v_dot2c_f32_bf16_dpp v10, v32, v209 row_newbcast:12 row_mask:0xf bank_mask:0xf
v_dot2c_f32_bf16_dpp v11, v33, v209 row_newbcast:12 row_mask:0xf bank_mask:0xf
v_dot2c_f32_bf16_dpp v12, v32, v210 row_newbcast:12 row_mask:0xf bank_mask:0xf
v_dot2c_f32_bf16_dpp v13, v33, v210 row_newbcast:12 row_mask:0xf bank_mask:0xf
v_dot2c_f32_bf16_dpp v14, v32, v211 row_newbcast:12 row_mask:0xf bank_mask:0xf
v_dot2c_f32_bf16_dpp v15, v33, v211 row_newbcast:12 row_mask:0xf bank_mask:0xf
s_mov_b32 s58, 262144
buffer_load_dwordx4 v[196:199], v2, s[28:31], s58 offen offset:0 nt
buffer_load_dwordx4 v[200:203], v2, s[28:31], s58 offen offset:1024 nt
buffer_load_dwordx4 v[204:207], v2, s[28:31], s58 offen offset:2048 nt
buffer_load_dwordx4 v[208:211], v2, s[28:31], s58 offen offset:3072 nt
s_mov_b32 s58, 229376
buffer_load_dwordx4 v[80:83], v113, s[40:43], s58 offen
s_mov_b32 s58, 258048
buffer_load_dwordx4 v[84:87], v113, s[40:43], s58 offen
s_mov_b32 s58, 286720
buffer_load_dwordx4 v[88:91], v113, s[40:43], s58 offen
s_mov_b32 s58, 315392
buffer_load_dwordx4 v[92:95], v113, s[40:43], s58 offen
s_mov_b32 s58, 344064
buffer_load_dwordx4 v[96:99], v113, s[40:43], s58 offen
s_mov_b32 s58, 372736
buffer_load_dwordx4 v[100:103], v113, s[40:43], s58 offen
s_mov_b32 s58, 401408
buffer_load_dwordx4 v[104:107], v113, s[40:43], s58 offen
s_mov_b32 s58, 430080
buffer_load_dwordx4 v[108:111], v113, s[40:43], s58 offen
s_waitcnt vmcnt(36)
v_dot2_f32_bf16 v22, v212, v4, 0
v_dot2_f32_bf16 v23, v216, v4, 0
v_dot2_f32_bf16 v24, v220, v4, 0
v_dot2_f32_bf16 v25, v224, v4, 0
v_dot2c_f32_bf16 v22, v213, v5
v_dot2c_f32_bf16 v23, v217, v5
v_dot2c_f32_bf16 v24, v221, v5
v_dot2c_f32_bf16 v25, v225, v5
v_dot2c_f32_bf16 v22, v214, v6
v_dot2c_f32_bf16 v23, v218, v6
v_dot2c_f32_bf16 v24, v222, v6
v_dot2c_f32_bf16 v25, v226, v6
v_dot2c_f32_bf16 v22, v215, v7
v_dot2c_f32_bf16 v23, v219, v7
v_dot2c_f32_bf16 v24, v223, v7
v_dot2c_f32_bf16 v25, v227, v7
s_mov_b32 s58, 327680
buffer_load_dwordx4 v[212:215], v2, s[24:27], s58 offen offset:0 nt
buffer_load_dwordx4 v[216:219], v2, s[24:27], s58 offen offset:1024 nt
buffer_load_dwordx4 v[220:223], v2, s[24:27], s58 offen offset:2048 nt
buffer_load_dwordx4 v[224:227], v2, s[24:27], s58 offen offset:3072 nt
v_add_f32_dpp v26, v22, v22 row_ror:8 row_mask:0xf bank_mask:0x3
v_add_f32_dpp v27, v23, v23 row_ror:8 row_mask:0xf bank_mask:0x3
s_nop 0
v_add_f32_dpp v26, v24, v24 row_ror:8 row_mask:0xf bank_mask:0xc
v_add_f32_dpp v27, v25, v25 row_ror:8 row_mask:0xf bank_mask:0xc
s_nop 0
v_add_f32_dpp v28, v26, v26 row_half_mirror row_mask:0xf bank_mask:0x5
s_nop 1
v_add_f32_dpp v28, v27, v27 row_half_mirror row_mask:0xf bank_mask:0xa
s_nop 1
v_add_f32_dpp v28, v28, v28 quad_perm:[1,0,3,2] row_mask:0xf bank_mask:0xf
s_nop 1
v_add_f32_dpp v28, v28, v28 quad_perm:[2,3,0,1] row_mask:0xf bank_mask:0xf
v_cvt_pk_bf16_f32 v28, v28, v28
v_and_b32 v28, s62, v28
v_mul_f32 v28, s60, v28
v_cvt_pk_bf16_f32 v28, v28, v28
v_and_b32 v28, s62, v28
s_nop 1
v_max_f32_dpp v29, v28, v28 row_ror:8 row_mask:0xf bank_mask:0xf
s_nop 1
v_max_f32_dpp v29, v29, v29 row_ror:4 row_mask:0xf bank_mask:0xf
v_max_f32 v29, v29, v16
v_sub_f32 v30, v16, v29
v_sub_f32 v31, v28, v29
v_mov_b32 v16, v29
v_mul_f32 v30, s61, v30
v_mul_f32 v31, s61, v31
v_exp_f32 v30, v30
v_exp_f32 v31, v31
s_nop 0
v_fma_f32 v17, v17, v30, v31
v_cvt_pk_bf16_f32 v32, v31, 0
v_cvt_pk_bf16_f32 v33, 0, v31
v_mul_f32 v8, v8, v30
v_mul_f32 v9, v9, v30
v_mul_f32 v10, v10, v30
v_mul_f32 v11, v11, v30
v_mul_f32 v12, v12, v30
v_mul_f32 v13, v13, v30
v_mul_f32 v14, v14, v30
v_mul_f32 v15, v15, v30
s_waitcnt vmcnt(36)
v_dot2c_f32_bf16_dpp v8, v32, v228 row_newbcast:0 row_mask:0xf bank_mask:0xf
v_dot2c_f32_bf16_dpp v9, v33, v228 row_newbcast:0 row_mask:0xf bank_mask:0xf
v_dot2c_f32_bf16_dpp v10, v32, v229 row_newbcast:0 row_mask:0xf bank_mask:0xf
v_dot2c_f32_bf16_dpp v11, v33, v229 row_newbcast:0 row_mask:0xf bank_mask:0xf
v_dot2c_f32_bf16_dpp v12, v32, v230 row_newbcast:0 row_mask:0xf bank_mask:0xf
v_dot2c_f32_bf16_dpp v13, v33, v230 row_newbcast:0 row_mask:0xf bank_mask:0xf
v_dot2c_f32_bf16_dpp v14, v32, v231 row_newbcast:0 row_mask:0xf bank_mask:0xf
v_dot2c_f32_bf16_dpp v15, v33, v231 row_newbcast:0 row_mask:0xf bank_mask:0xf
v_dot2c_f32_bf16_dpp v8, v32, v232 row_newbcast:4 row_mask:0xf bank_mask:0xf
v_dot2c_f32_bf16_dpp v9, v33, v232 row_newbcast:4 row_mask:0xf bank_mask:0xf
v_dot2c_f32_bf16_dpp v10, v32, v233 row_newbcast:4 row_mask:0xf bank_mask:0xf
v_dot2c_f32_bf16_dpp v11, v33, v233 row_newbcast:4 row_mask:0xf bank_mask:0xf
v_dot2c_f32_bf16_dpp v12, v32, v234 row_newbcast:4 row_mask:0xf bank_mask:0xf
v_dot2c_f32_bf16_dpp v13, v33, v234 row_newbcast:4 row_mask:0xf bank_mask:0xf
v_dot2c_f32_bf16_dpp v14, v32, v235 row_newbcast:4 row_mask:0xf bank_mask:0xf
v_dot2c_f32_bf16_dpp v15, v33, v235 row_newbcast:4 row_mask:0xf bank_mask:0xf
v_dot2c_f32_bf16_dpp v8, v32, v236 row_newbcast:8 row_mask:0xf bank_mask:0xf
v_dot2c_f32_bf16_dpp v9, v33, v236 row_newbcast:8 row_mask:0xf bank_mask:0xf
v_dot2c_f32_bf16_dpp v10, v32, v237 row_newbcast:8 row_mask:0xf bank_mask:0xf
v_dot2c_f32_bf16_dpp v11, v33, v237 row_newbcast:8 row_mask:0xf bank_mask:0xf
v_dot2c_f32_bf16_dpp v12, v32, v238 row_newbcast:8 row_mask:0xf bank_mask:0xf
v_dot2c_f32_bf16_dpp v13, v33, v238 row_newbcast:8 row_mask:0xf bank_mask:0xf
v_dot2c_f32_bf16_dpp v14, v32, v239 row_newbcast:8 row_mask:0xf bank_mask:0xf
v_dot2c_f32_bf16_dpp v15, v33, v239 row_newbcast:8 row_mask:0xf bank_mask:0xf
v_dot2c_f32_bf16_dpp v8, v32, v240 row_newbcast:12 row_mask:0xf bank_mask:0xf
v_dot2c_f32_bf16_dpp v9, v33, v240 row_newbcast:12 row_mask:0xf bank_mask:0xf
v_dot2c_f32_bf16_dpp v10, v32, v241 row_newbcast:12 row_mask:0xf bank_mask:0xf
v_dot2c_f32_bf16_dpp v11, v33, v241 row_newbcast:12 row_mask:0xf bank_mask:0xf
v_dot2c_f32_bf16_dpp v12, v32, v242 row_newbcast:12 row_mask:0xf bank_mask:0xf
v_dot2c_f32_bf16_dpp v13, v33, v242 row_newbcast:12 row_mask:0xf bank_mask:0xf
v_dot2c_f32_bf16_dpp v14, v32, v243 row_newbcast:12 row_mask:0xf bank_mask:0xf
v_dot2c_f32_bf16_dpp v15, v33, v243 row_newbcast:12 row_mask:0xf bank_mask:0xf
s_mov_b32 s58, 327680
buffer_load_dwordx4 v[228:231], v2, s[28:31], s58 offen offset:0 nt
buffer_load_dwordx4 v[232:235], v2, s[28:31], s58 offen offset:1024 nt
buffer_load_dwordx4 v[236:239], v2, s[28:31], s58 offen offset:2048 nt
buffer_load_dwordx4 v[240:243], v2, s[28:31], s58 offen offset:3072 nt
s_waitcnt vmcnt(36)
v_dot2_f32_bf16 v22, v148, v4, 0
v_dot2_f32_bf16 v23, v152, v4, 0
v_dot2_f32_bf16 v24, v156, v4, 0
v_dot2_f32_bf16 v25, v160, v4, 0
v_dot2c_f32_bf16 v22, v149, v5
v_dot2c_f32_bf16 v23, v153, v5
v_dot2c_f32_bf16 v24, v157, v5
v_dot2c_f32_bf16 v25, v161, v5
v_dot2c_f32_bf16 v22, v150, v6
v_dot2c_f32_bf16 v23, v154, v6
v_dot2c_f32_bf16 v24, v158, v6
v_dot2c_f32_bf16 v25, v162, v6
v_dot2c_f32_bf16 v22, v151, v7
v_dot2c_f32_bf16 v23, v155, v7
v_dot2c_f32_bf16 v24, v159, v7
v_dot2c_f32_bf16 v25, v163, v7
s_mov_b32 s58, 393216
buffer_load_dwordx4 v[148:151], v2, s[24:27], s58 offen offset:0 nt
buffer_load_dwordx4 v[152:155], v2, s[24:27], s58 offen offset:1024 nt
buffer_load_dwordx4 v[156:159], v2, s[24:27], s58 offen offset:2048 nt
buffer_load_dwordx4 v[160:163], v2, s[24:27], s58 offen offset:3072 nt
v_add_f32_dpp v26, v22, v22 row_ror:8 row_mask:0xf bank_mask:0x3
v_add_f32_dpp v27, v23, v23 row_ror:8 row_mask:0xf bank_mask:0x3
s_nop 0
v_add_f32_dpp v26, v24, v24 row_ror:8 row_mask:0xf bank_mask:0xc
v_add_f32_dpp v27, v25, v25 row_ror:8 row_mask:0xf bank_mask:0xc
s_nop 0
v_add_f32_dpp v28, v26, v26 row_half_mirror row_mask:0xf bank_mask:0x5
s_nop 1
v_add_f32_dpp v28, v27, v27 row_half_mirror row_mask:0xf bank_mask:0xa
s_nop 1
v_add_f32_dpp v28, v28, v28 quad_perm:[1,0,3,2] row_mask:0xf bank_mask:0xf
s_nop 1
v_add_f32_dpp v28, v28, v28 quad_perm:[2,3,0,1] row_mask:0xf bank_mask:0xf
v_cvt_pk_bf16_f32 v28, v28, v28
v_and_b32 v28, s62, v28
v_mul_f32 v28, s60, v28
v_cvt_pk_bf16_f32 v28, v28, v28
v_and_b32 v28, s62, v28
s_nop 1
v_max_f32_dpp v29, v28, v28 row_ror:8 row_mask:0xf bank_mask:0xf
s_nop 1
v_max_f32_dpp v29, v29, v29 row_ror:4 row_mask:0xf bank_mask:0xf
v_max_f32 v29, v29, v16
v_sub_f32 v30, v16, v29
v_sub_f32 v31, v28, v29
v_mov_b32 v16, v29
v_mul_f32 v30, s61, v30
v_mul_f32 v31, s61, v31
v_exp_f32 v30, v30
v_exp_f32 v31, v31
s_nop 0
v_fma_f32 v17, v17, v30, v31
v_cvt_pk_bf16_f32 v32, v31, 0
v_cvt_pk_bf16_f32 v33, 0, v31
v_mul_f32 v8, v8, v30
v_mul_f32 v9, v9, v30
v_mul_f32 v10, v10, v30
v_mul_f32 v11, v11, v30
v_mul_f32 v12, v12, v30
v_mul_f32 v13, v13, v30
v_mul_f32 v14, v14, v30
v_mul_f32 v15, v15, v30
s_waitcnt vmcnt(36)
v_dot2c_f32_bf16_dpp v8, v32, v164 row_newbcast:0 row_mask:0xf bank_mask:0xf
v_dot2c_f32_bf16_dpp v9, v33, v164 row_newbcast:0 row_mask:0xf bank_mask:0xf
v_dot2c_f32_bf16_dpp v10, v32, v165 row_newbcast:0 row_mask:0xf bank_mask:0xf
v_dot2c_f32_bf16_dpp v11, v33, v165 row_newbcast:0 row_mask:0xf bank_mask:0xf
v_dot2c_f32_bf16_dpp v12, v32, v166 row_newbcast:0 row_mask:0xf bank_mask:0xf
v_dot2c_f32_bf16_dpp v13, v33, v166 row_newbcast:0 row_mask:0xf bank_mask:0xf
v_dot2c_f32_bf16_dpp v14, v32, v167 row_newbcast:0 row_mask:0xf bank_mask:0xf
v_dot2c_f32_bf16_dpp v15, v33, v167 row_newbcast:0 row_mask:0xf bank_mask:0xf
v_dot2c_f32_bf16_dpp v8, v32, v168 row_newbcast:4 row_mask:0xf bank_mask:0xf
v_dot2c_f32_bf16_dpp v9, v33, v168 row_newbcast:4 row_mask:0xf bank_mask:0xf
v_dot2c_f32_bf16_dpp v10, v32, v169 row_newbcast:4 row_mask:0xf bank_mask:0xf
v_dot2c_f32_bf16_dpp v11, v33, v169 row_newbcast:4 row_mask:0xf bank_mask:0xf
v_dot2c_f32_bf16_dpp v12, v32, v170 row_newbcast:4 row_mask:0xf bank_mask:0xf
v_dot2c_f32_bf16_dpp v13, v33, v170 row_newbcast:4 row_mask:0xf bank_mask:0xf
v_dot2c_f32_bf16_dpp v14, v32, v171 row_newbcast:4 row_mask:0xf bank_mask:0xf
v_dot2c_f32_bf16_dpp v15, v33, v171 row_newbcast:4 row_mask:0xf bank_mask:0xf
v_dot2c_f32_bf16_dpp v8, v32, v172 row_newbcast:8 row_mask:0xf bank_mask:0xf
v_dot2c_f32_bf16_dpp v9, v33, v172 row_newbcast:8 row_mask:0xf bank_mask:0xf
v_dot2c_f32_bf16_dpp v10, v32, v173 row_newbcast:8 row_mask:0xf bank_mask:0xf
v_dot2c_f32_bf16_dpp v11, v33, v173 row_newbcast:8 row_mask:0xf bank_mask:0xf
v_dot2c_f32_bf16_dpp v12, v32, v174 row_newbcast:8 row_mask:0xf bank_mask:0xf
v_dot2c_f32_bf16_dpp v13, v33, v174 row_newbcast:8 row_mask:0xf bank_mask:0xf
v_dot2c_f32_bf16_dpp v14, v32, v175 row_newbcast:8 row_mask:0xf bank_mask:0xf
v_dot2c_f32_bf16_dpp v15, v33, v175 row_newbcast:8 row_mask:0xf bank_mask:0xf
v_dot2c_f32_bf16_dpp v8, v32, v176 row_newbcast:12 row_mask:0xf bank_mask:0xf
v_dot2c_f32_bf16_dpp v9, v33, v176 row_newbcast:12 row_mask:0xf bank_mask:0xf
v_dot2c_f32_bf16_dpp v10, v32, v177 row_newbcast:12 row_mask:0xf bank_mask:0xf
v_dot2c_f32_bf16_dpp v11, v33, v177 row_newbcast:12 row_mask:0xf bank_mask:0xf
v_dot2c_f32_bf16_dpp v12, v32, v178 row_newbcast:12 row_mask:0xf bank_mask:0xf
v_dot2c_f32_bf16_dpp v13, v33, v178 row_newbcast:12 row_mask:0xf bank_mask:0xf
v_dot2c_f32_bf16_dpp v14, v32, v179 row_newbcast:12 row_mask:0xf bank_mask:0xf
v_dot2c_f32_bf16_dpp v15, v33, v179 row_newbcast:12 row_mask:0xf bank_mask:0xf
s_mov_b32 s58, 393216
buffer_load_dwordx4 v[164:167], v2, s[28:31], s58 offen offset:0 nt
buffer_load_dwordx4 v[168:171], v2, s[28:31], s58 offen offset:1024 nt
buffer_load_dwordx4 v[172:175], v2, s[28:31], s58 offen offset:2048 nt
buffer_load_dwordx4 v[176:179], v2, s[28:31], s58 offen offset:3072 nt
s_lshl_b32 s59, s48, 9
v_lshrrev_b32 v39, 3, v19
v_lshl_add_u32 v39, v39, 2, v18
v_lshlrev_b32 v39, 2, v39
v_add_u32 v39, s59, v39
v_mov_b32 v30, 0
v_mov_b32 v31, 0
v_mov_b32 v32, 0
v_mov_b32 v33, 0
v_mov_b32 v34, 0
v_mov_b32 v35, 0
v_mov_b32 v36, 0
v_mov_b32 v37, 0
ds_read_b32 v22, v39 offset:0
ds_read_b32 v23, v39 offset:32
ds_read_b32 v24, v39 offset:64
ds_read_b32 v25, v39 offset:96
ds_read_b32 v26, v39 offset:128
ds_read_b32 v27, v39 offset:160
ds_read_b32 v28, v39 offset:192
ds_read_b32 v29, v39 offset:224
s_waitcnt lgkmcnt(0)
v_lshlrev_b32 v40, 16, v22
v_lshlrev_b32 v41, 16, v23
v_lshlrev_b32 v42, 16, v24
v_lshlrev_b32 v43, 16, v25
v_lshlrev_b32 v44, 16, v26
v_lshlrev_b32 v45, 16, v27
v_lshlrev_b32 v46, 16, v28
v_lshlrev_b32 v47, 16, v29
s_waitcnt vmcnt(16)
v_dot2c_f32_bf16 v30, v22, v48
v_dot2c_f32_bf16 v31, v40, v48
v_dot2c_f32_bf16 v32, v22, v49
v_dot2c_f32_bf16 v33, v40, v49
v_dot2c_f32_bf16 v34, v22, v50
v_dot2c_f32_bf16 v35, v40, v50
v_dot2c_f32_bf16 v36, v22, v51
v_dot2c_f32_bf16 v37, v40, v51
v_dot2c_f32_bf16 v30, v23, v52
v_dot2c_f32_bf16 v31, v41, v52
v_dot2c_f32_bf16 v32, v23, v53
v_dot2c_f32_bf16 v33, v41, v53
v_dot2c_f32_bf16 v34, v23, v54
v_dot2c_f32_bf16 v35, v41, v54
v_dot2c_f32_bf16 v36, v23, v55
v_dot2c_f32_bf16 v37, v41, v55
v_dot2c_f32_bf16 v30, v24, v56
v_dot2c_f32_bf16 v31, v42, v56
v_dot2c_f32_bf16 v32, v24, v57
v_dot2c_f32_bf16 v33, v42, v57
v_dot2c_f32_bf16 v34, v24, v58
v_dot2c_f32_bf16 v35, v42, v58
v_dot2c_f32_bf16 v36, v24, v59
v_dot2c_f32_bf16 v37, v42, v59
v_dot2c_f32_bf16 v30, v25, v60
v_dot2c_f32_bf16 v31, v43, v60
v_dot2c_f32_bf16 v32, v25, v61
v_dot2c_f32_bf16 v33, v43, v61
v_dot2c_f32_bf16 v34, v25, v62
v_dot2c_f32_bf16 v35, v43, v62
v_dot2c_f32_bf16 v36, v25, v63
v_dot2c_f32_bf16 v37, v43, v63
v_dot2c_f32_bf16 v30, v26, v64
v_dot2c_f32_bf16 v31, v44, v64
v_dot2c_f32_bf16 v32, v26, v65
v_dot2c_f32_bf16 v33, v44, v65
v_dot2c_f32_bf16 v34, v26, v66
v_dot2c_f32_bf16 v35, v44, v66
v_dot2c_f32_bf16 v36, v26, v67
v_dot2c_f32_bf16 v37, v44, v67
v_dot2c_f32_bf16 v30, v27, v68
v_dot2c_f32_bf16 v31, v45, v68
v_dot2c_f32_bf16 v32, v27, v69
v_dot2c_f32_bf16 v33, v45, v69
v_dot2c_f32_bf16 v34, v27, v70
v_dot2c_f32_bf16 v35, v45, v70
v_dot2c_f32_bf16 v36, v27, v71
v_dot2c_f32_bf16 v37, v45, v71
v_dot2c_f32_bf16 v30, v28, v72
v_dot2c_f32_bf16 v31, v46, v72
v_dot2c_f32_bf16 v32, v28, v73
v_dot2c_f32_bf16 v33, v46, v73
v_dot2c_f32_bf16 v34, v28, v74
v_dot2c_f32_bf16 v35, v46, v74
v_dot2c_f32_bf16 v36, v28, v75
v_dot2c_f32_bf16 v37, v46, v75
v_dot2c_f32_bf16 v30, v29, v76
v_dot2c_f32_bf16 v31, v47, v76
v_dot2c_f32_bf16 v32, v29, v77
v_dot2c_f32_bf16 v33, v47, v77
v_dot2c_f32_bf16 v34, v29, v78
v_dot2c_f32_bf16 v35, v47, v78
v_dot2c_f32_bf16 v36, v29, v79
v_dot2c_f32_bf16 v37, v47, v79
ds_read_b32 v22, v39 offset:256
ds_read_b32 v23, v39 offset:288
ds_read_b32 v24, v39 offset:320
ds_read_b32 v25, v39 offset:352
ds_read_b32 v26, v39 offset:384
ds_read_b32 v27, v39 offset:416
ds_read_b32 v28, v39 offset:448
ds_read_b32 v29, v39 offset:480
s_waitcnt lgkmcnt(0)
v_lshlrev_b32 v40, 16, v22
v_lshlrev_b32 v41, 16, v23
v_lshlrev_b32 v42, 16, v24
v_lshlrev_b32 v43, 16, v25
v_lshlrev_b32 v44, 16, v26
v_lshlrev_b32 v45, 16, v27
v_lshlrev_b32 v46, 16, v28
v_lshlrev_b32 v47, 16, v29
v_dot2c_f32_bf16 v30, v22, v80
v_dot2c_f32_bf16 v31, v40, v80
v_dot2c_f32_bf16 v32, v22, v81
v_dot2c_f32_bf16 v33, v40, v81
v_dot2c_f32_bf16 v34, v22, v82
v_dot2c_f32_bf16 v35, v40, v82
v_dot2c_f32_bf16 v36, v22, v83
v_dot2c_f32_bf16 v37, v40, v83
v_dot2c_f32_bf16 v30, v23, v84
v_dot2c_f32_bf16 v31, v41, v84
v_dot2c_f32_bf16 v32, v23, v85
v_dot2c_f32_bf16 v33, v41, v85
v_dot2c_f32_bf16 v34, v23, v86
v_dot2c_f32_bf16 v35, v41, v86
v_dot2c_f32_bf16 v36, v23, v87
v_dot2c_f32_bf16 v37, v41, v87
v_dot2c_f32_bf16 v30, v24, v88
v_dot2c_f32_bf16 v31, v42, v88
v_dot2c_f32_bf16 v32, v24, v89
v_dot2c_f32_bf16 v33, v42, v89
v_dot2c_f32_bf16 v34, v24, v90
v_dot2c_f32_bf16 v35, v42, v90
v_dot2c_f32_bf16 v36, v24, v91
v_dot2c_f32_bf16 v37, v42, v91
v_dot2c_f32_bf16 v30, v25, v92
v_dot2c_f32_bf16 v31, v43, v92
v_dot2c_f32_bf16 v32, v25, v93
v_dot2c_f32_bf16 v33, v43, v93
v_dot2c_f32_bf16 v34, v25, v94
v_dot2c_f32_bf16 v35, v43, v94
v_dot2c_f32_bf16 v36, v25, v95
v_dot2c_f32_bf16 v37, v43, v95
v_dot2c_f32_bf16 v30, v26, v96
v_dot2c_f32_bf16 v31, v44, v96
v_dot2c_f32_bf16 v32, v26, v97
v_dot2c_f32_bf16 v33, v44, v97
v_dot2c_f32_bf16 v34, v26, v98
v_dot2c_f32_bf16 v35, v44, v98
v_dot2c_f32_bf16 v36, v26, v99
v_dot2c_f32_bf16 v37, v44, v99
v_dot2c_f32_bf16 v30, v27, v100
v_dot2c_f32_bf16 v31, v45, v100
v_dot2c_f32_bf16 v32, v27, v101
v_dot2c_f32_bf16 v33, v45, v101
v_dot2c_f32_bf16 v34, v27, v102
v_dot2c_f32_bf16 v35, v45, v102
v_dot2c_f32_bf16 v36, v27, v103
v_dot2c_f32_bf16 v37, v45, v103
v_dot2c_f32_bf16 v30, v28, v104
v_dot2c_f32_bf16 v31, v46, v104
v_dot2c_f32_bf16 v32, v28, v105
v_dot2c_f32_bf16 v33, v46, v105
v_dot2c_f32_bf16 v34, v28, v106
v_dot2c_f32_bf16 v35, v46, v106
v_dot2c_f32_bf16 v36, v28, v107
v_dot2c_f32_bf16 v37, v46, v107
v_dot2c_f32_bf16 v30, v29, v108
v_dot2c_f32_bf16 v31, v47, v108
v_dot2c_f32_bf16 v32, v29, v109
v_dot2c_f32_bf16 v33, v47, v109
v_dot2c_f32_bf16 v34, v29, v110
v_dot2c_f32_bf16 v35, v47, v110
v_dot2c_f32_bf16 v36, v29, v111
v_dot2c_f32_bf16 v37, v47, v111
v_permlane32_swap_b32 v30, v34
v_permlane32_swap_b32 v31, v35
v_permlane32_swap_b32 v32, v36
v_permlane32_swap_b32 v33, v37
v_add_f32 v30, v30, v34
v_add_f32 v31, v31, v35
v_add_f32 v32, v32, v36
v_add_f32 v33, v33, v37
s_nop 0
v_permlane16_swap_b32 v30, v32
v_permlane16_swap_b32 v31, v33
v_add_f32 v30, v30, v32
v_add_f32 v31, v31, v33
s_nop 0
v_add_f32_dpp v30, v30, v30 row_ror:8 row_mask:0xf bank_mask:0xf
v_add_f32_dpp v31, v31, v31 row_ror:8 row_mask:0xf bank_mask:0xf
v_and_b32 v38, 7, v19
v_lshl_add_u32 v38, v38, 2, v18
v_lshlrev_b32 v38, 3, v38
s_lshl_b32 s59, s48, 8
v_add_u32 v38, s59, v38
ds_write_b64 v38, v[30:31] offset:4096
v_mov_b32 v22, 0
v_mov_b32 v23, 1
s_waitcnt lgkmcnt(0)
s_mov_b64 exec, 1
ds_add_u32 v22, v23 offset:9608
s_mov_b64 exec, -1
s_mov_b32 s58, 0
buffer_load_dwordx4 v[48:51], v114, s[44:47], s58 offen offset:0
buffer_load_dwordx4 v[52:55], v114, s[44:47], s58 offen offset:1024
buffer_load_dwordx4 v[56:59], v114, s[44:47], s58 offen offset:2048
buffer_load_dwordx4 v[60:63], v114, s[44:47], s58 offen offset:3072
s_mov_b32 s58, 4096
buffer_load_dwordx4 v[64:67], v114, s[44:47], s58 offen offset:0
buffer_load_dwordx4 v[68:71], v114, s[44:47], s58 offen offset:1024
buffer_load_dwordx4 v[72:75], v114, s[44:47], s58 offen offset:2048
buffer_load_dwordx4 v[76:79], v114, s[44:47], s58 offen offset:3072
s_mov_b32 s58, 8192
buffer_load_dwordx4 v[80:83], v114, s[44:47], s58 offen offset:0
buffer_load_dwordx4 v[84:87], v114, s[44:47], s58 offen offset:1024
buffer_load_dwordx4 v[88:91], v114, s[44:47], s58 offen offset:2048
buffer_load_dwordx4 v[92:95], v114, s[44:47], s58 offen offset:3072
s_mov_b32 s58, 12288
buffer_load_dwordx4 v[96:99], v114, s[44:47], s58 offen offset:0
buffer_load_dwordx4 v[100:103], v114, s[44:47], s58 offen offset:1024
buffer_load_dwordx4 v[104:107], v114, s[44:47], s58 offen offset:2048
buffer_load_dwordx4 v[108:111], v114, s[44:47], s58 offen offset:3072
v_dot2_f32_bf16 v22, v180, v4, 0
v_dot2_f32_bf16 v23, v184, v4, 0
v_dot2_f32_bf16 v24, v188, v4, 0
v_dot2_f32_bf16 v25, v192, v4, 0
v_dot2c_f32_bf16 v22, v181, v5
v_dot2c_f32_bf16 v23, v185, v5
v_dot2c_f32_bf16 v24, v189, v5
v_dot2c_f32_bf16 v25, v193, v5
v_dot2c_f32_bf16 v22, v182, v6
v_dot2c_f32_bf16 v23, v186, v6
v_dot2c_f32_bf16 v24, v190, v6
v_dot2c_f32_bf16 v25, v194, v6
v_dot2c_f32_bf16 v22, v183, v7
v_dot2c_f32_bf16 v23, v187, v7
v_dot2c_f32_bf16 v24, v191, v7
v_dot2c_f32_bf16 v25, v195, v7
s_mov_b32 s58, 458752
buffer_load_dwordx4 v[180:183], v2, s[24:27], s58 offen offset:0 nt
buffer_load_dwordx4 v[184:187], v2, s[24:27], s58 offen offset:1024 nt
buffer_load_dwordx4 v[188:191], v2, s[24:27], s58 offen offset:2048 nt
buffer_load_dwordx4 v[192:195], v2, s[24:27], s58 offen offset:3072 nt
v_add_f32_dpp v26, v22, v22 row_ror:8 row_mask:0xf bank_mask:0x3
v_add_f32_dpp v27, v23, v23 row_ror:8 row_mask:0xf bank_mask:0x3
s_nop 0
v_add_f32_dpp v26, v24, v24 row_ror:8 row_mask:0xf bank_mask:0xc
v_add_f32_dpp v27, v25, v25 row_ror:8 row_mask:0xf bank_mask:0xc
s_nop 0
v_add_f32_dpp v28, v26, v26 row_half_mirror row_mask:0xf bank_mask:0x5
s_nop 1
v_add_f32_dpp v28, v27, v27 row_half_mirror row_mask:0xf bank_mask:0xa
s_nop 1
v_add_f32_dpp v28, v28, v28 quad_perm:[1,0,3,2] row_mask:0xf bank_mask:0xf
s_nop 1
v_add_f32_dpp v28, v28, v28 quad_perm:[2,3,0,1] row_mask:0xf bank_mask:0xf
v_cvt_pk_bf16_f32 v28, v28, v28
v_and_b32 v28, s62, v28
v_mul_f32 v28, s60, v28
v_cvt_pk_bf16_f32 v28, v28, v28
v_and_b32 v28, s62, v28
s_nop 1
v_max_f32_dpp v29, v28, v28 row_ror:8 row_mask:0xf bank_mask:0xf
s_nop 1
v_max_f32_dpp v29, v29, v29 row_ror:4 row_mask:0xf bank_mask:0xf
v_max_f32 v29, v29, v16
v_sub_f32 v30, v16, v29
v_sub_f32 v31, v28, v29
v_mov_b32 v16, v29
v_mul_f32 v30, s61, v30
v_mul_f32 v31, s61, v31
v_exp_f32 v30, v30
v_exp_f32 v31, v31
s_nop 0
v_fma_f32 v17, v17, v30, v31
v_cvt_pk_bf16_f32 v32, v31, 0
v_cvt_pk_bf16_f32 v33, 0, v31
v_mul_f32 v8, v8, v30
v_mul_f32 v9, v9, v30
v_mul_f32 v10, v10, v30
v_mul_f32 v11, v11, v30
v_mul_f32 v12, v12, v30
v_mul_f32 v13, v13, v30
v_mul_f32 v14, v14, v30
v_mul_f32 v15, v15, v30
v_dot2c_f32_bf16_dpp v8, v32, v196 row_newbcast:0 row_mask:0xf bank_mask:0xf
v_dot2c_f32_bf16_dpp v9, v33, v196 row_newbcast:0 row_mask:0xf bank_mask:0xf
v_dot2c_f32_bf16_dpp v10, v32, v197 row_newbcast:0 row_mask:0xf bank_mask:0xf
v_dot2c_f32_bf16_dpp v11, v33, v197 row_newbcast:0 row_mask:0xf bank_mask:0xf
v_dot2c_f32_bf16_dpp v12, v32, v198 row_newbcast:0 row_mask:0xf bank_mask:0xf
v_dot2c_f32_bf16_dpp v13, v33, v198 row_newbcast:0 row_mask:0xf bank_mask:0xf
v_dot2c_f32_bf16_dpp v14, v32, v199 row_newbcast:0 row_mask:0xf bank_mask:0xf
v_dot2c_f32_bf16_dpp v15, v33, v199 row_newbcast:0 row_mask:0xf bank_mask:0xf
v_dot2c_f32_bf16_dpp v8, v32, v200 row_newbcast:4 row_mask:0xf bank_mask:0xf
v_dot2c_f32_bf16_dpp v9, v33, v200 row_newbcast:4 row_mask:0xf bank_mask:0xf
v_dot2c_f32_bf16_dpp v10, v32, v201 row_newbcast:4 row_mask:0xf bank_mask:0xf
v_dot2c_f32_bf16_dpp v11, v33, v201 row_newbcast:4 row_mask:0xf bank_mask:0xf
v_dot2c_f32_bf16_dpp v12, v32, v202 row_newbcast:4 row_mask:0xf bank_mask:0xf
v_dot2c_f32_bf16_dpp v13, v33, v202 row_newbcast:4 row_mask:0xf bank_mask:0xf
v_dot2c_f32_bf16_dpp v14, v32, v203 row_newbcast:4 row_mask:0xf bank_mask:0xf
v_dot2c_f32_bf16_dpp v15, v33, v203 row_newbcast:4 row_mask:0xf bank_mask:0xf
v_dot2c_f32_bf16_dpp v8, v32, v204 row_newbcast:8 row_mask:0xf bank_mask:0xf
v_dot2c_f32_bf16_dpp v9, v33, v204 row_newbcast:8 row_mask:0xf bank_mask:0xf
v_dot2c_f32_bf16_dpp v10, v32, v205 row_newbcast:8 row_mask:0xf bank_mask:0xf
v_dot2c_f32_bf16_dpp v11, v33, v205 row_newbcast:8 row_mask:0xf bank_mask:0xf
v_dot2c_f32_bf16_dpp v12, v32, v206 row_newbcast:8 row_mask:0xf bank_mask:0xf
v_dot2c_f32_bf16_dpp v13, v33, v206 row_newbcast:8 row_mask:0xf bank_mask:0xf
v_dot2c_f32_bf16_dpp v14, v32, v207 row_newbcast:8 row_mask:0xf bank_mask:0xf
v_dot2c_f32_bf16_dpp v15, v33, v207 row_newbcast:8 row_mask:0xf bank_mask:0xf
v_dot2c_f32_bf16_dpp v8, v32, v208 row_newbcast:12 row_mask:0xf bank_mask:0xf
v_dot2c_f32_bf16_dpp v9, v33, v208 row_newbcast:12 row_mask:0xf bank_mask:0xf
v_dot2c_f32_bf16_dpp v10, v32, v209 row_newbcast:12 row_mask:0xf bank_mask:0xf
v_dot2c_f32_bf16_dpp v11, v33, v209 row_newbcast:12 row_mask:0xf bank_mask:0xf
v_dot2c_f32_bf16_dpp v12, v32, v210 row_newbcast:12 row_mask:0xf bank_mask:0xf
v_dot2c_f32_bf16_dpp v13, v33, v210 row_newbcast:12 row_mask:0xf bank_mask:0xf
v_dot2c_f32_bf16_dpp v14, v32, v211 row_newbcast:12 row_mask:0xf bank_mask:0xf
v_dot2c_f32_bf16_dpp v15, v33, v211 row_newbcast:12 row_mask:0xf bank_mask:0xf
s_mov_b32 s58, 458752
buffer_load_dwordx4 v[196:199], v2, s[28:31], s58 offen offset:0 nt
buffer_load_dwordx4 v[200:203], v2, s[28:31], s58 offen offset:1024 nt
buffer_load_dwordx4 v[204:207], v2, s[28:31], s58 offen offset:2048 nt
buffer_load_dwordx4 v[208:211], v2, s[28:31], s58 offen offset:3072 nt
s_waitcnt vmcnt(36)
v_dot2_f32_bf16 v22, v212, v4, 0
v_dot2_f32_bf16 v23, v216, v4, 0
v_dot2_f32_bf16 v24, v220, v4, 0
v_dot2_f32_bf16 v25, v224, v4, 0
v_dot2c_f32_bf16 v22, v213, v5
v_dot2c_f32_bf16 v23, v217, v5
v_dot2c_f32_bf16 v24, v221, v5
v_dot2c_f32_bf16 v25, v225, v5
v_dot2c_f32_bf16 v22, v214, v6
v_dot2c_f32_bf16 v23, v218, v6
v_dot2c_f32_bf16 v24, v222, v6
v_dot2c_f32_bf16 v25, v226, v6
v_dot2c_f32_bf16 v22, v215, v7
v_dot2c_f32_bf16 v23, v219, v7
v_dot2c_f32_bf16 v24, v223, v7
v_dot2c_f32_bf16 v25, v227, v7
s_mov_b32 s58, 524288
buffer_load_dwordx4 v[212:215], v2, s[24:27], s58 offen offset:0 nt
buffer_load_dwordx4 v[216:219], v2, s[24:27], s58 offen offset:1024 nt
buffer_load_dwordx4 v[220:223], v2, s[24:27], s58 offen offset:2048 nt
buffer_load_dwordx4 v[224:227], v2, s[24:27], s58 offen offset:3072 nt
v_add_f32_dpp v26, v22, v22 row_ror:8 row_mask:0xf bank_mask:0x3
v_add_f32_dpp v27, v23, v23 row_ror:8 row_mask:0xf bank_mask:0x3
s_nop 0
v_add_f32_dpp v26, v24, v24 row_ror:8 row_mask:0xf bank_mask:0xc
v_add_f32_dpp v27, v25, v25 row_ror:8 row_mask:0xf bank_mask:0xc
s_nop 0
v_add_f32_dpp v28, v26, v26 row_half_mirror row_mask:0xf bank_mask:0x5
s_nop 1
v_add_f32_dpp v28, v27, v27 row_half_mirror row_mask:0xf bank_mask:0xa
s_nop 1
v_add_f32_dpp v28, v28, v28 quad_perm:[1,0,3,2] row_mask:0xf bank_mask:0xf
s_nop 1
v_add_f32_dpp v28, v28, v28 quad_perm:[2,3,0,1] row_mask:0xf bank_mask:0xf
v_cvt_pk_bf16_f32 v28, v28, v28
v_and_b32 v28, s62, v28
v_mul_f32 v28, s60, v28
v_cvt_pk_bf16_f32 v28, v28, v28
v_and_b32 v28, s62, v28
s_nop 1
v_max_f32_dpp v29, v28, v28 row_ror:8 row_mask:0xf bank_mask:0xf
s_nop 1
v_max_f32_dpp v29, v29, v29 row_ror:4 row_mask:0xf bank_mask:0xf
v_max_f32 v29, v29, v16
v_sub_f32 v30, v16, v29
v_sub_f32 v31, v28, v29
v_mov_b32 v16, v29
v_mul_f32 v30, s61, v30
v_mul_f32 v31, s61, v31
v_exp_f32 v30, v30
v_exp_f32 v31, v31
s_nop 0
v_fma_f32 v17, v17, v30, v31
v_cvt_pk_bf16_f32 v32, v31, 0
v_cvt_pk_bf16_f32 v33, 0, v31
v_mul_f32 v8, v8, v30
v_mul_f32 v9, v9, v30
v_mul_f32 v10, v10, v30
v_mul_f32 v11, v11, v30
v_mul_f32 v12, v12, v30
v_mul_f32 v13, v13, v30
v_mul_f32 v14, v14, v30
v_mul_f32 v15, v15, v30
s_waitcnt vmcnt(36)
v_dot2c_f32_bf16_dpp v8, v32, v228 row_newbcast:0 row_mask:0xf bank_mask:0xf
v_dot2c_f32_bf16_dpp v9, v33, v228 row_newbcast:0 row_mask:0xf bank_mask:0xf
v_dot2c_f32_bf16_dpp v10, v32, v229 row_newbcast:0 row_mask:0xf bank_mask:0xf
v_dot2c_f32_bf16_dpp v11, v33, v229 row_newbcast:0 row_mask:0xf bank_mask:0xf
v_dot2c_f32_bf16_dpp v12, v32, v230 row_newbcast:0 row_mask:0xf bank_mask:0xf
v_dot2c_f32_bf16_dpp v13, v33, v230 row_newbcast:0 row_mask:0xf bank_mask:0xf
v_dot2c_f32_bf16_dpp v14, v32, v231 row_newbcast:0 row_mask:0xf bank_mask:0xf
v_dot2c_f32_bf16_dpp v15, v33, v231 row_newbcast:0 row_mask:0xf bank_mask:0xf
v_dot2c_f32_bf16_dpp v8, v32, v232 row_newbcast:4 row_mask:0xf bank_mask:0xf
v_dot2c_f32_bf16_dpp v9, v33, v232 row_newbcast:4 row_mask:0xf bank_mask:0xf
v_dot2c_f32_bf16_dpp v10, v32, v233 row_newbcast:4 row_mask:0xf bank_mask:0xf
v_dot2c_f32_bf16_dpp v11, v33, v233 row_newbcast:4 row_mask:0xf bank_mask:0xf
v_dot2c_f32_bf16_dpp v12, v32, v234 row_newbcast:4 row_mask:0xf bank_mask:0xf
v_dot2c_f32_bf16_dpp v13, v33, v234 row_newbcast:4 row_mask:0xf bank_mask:0xf
v_dot2c_f32_bf16_dpp v14, v32, v235 row_newbcast:4 row_mask:0xf bank_mask:0xf
v_dot2c_f32_bf16_dpp v15, v33, v235 row_newbcast:4 row_mask:0xf bank_mask:0xf
v_dot2c_f32_bf16_dpp v8, v32, v236 row_newbcast:8 row_mask:0xf bank_mask:0xf
v_dot2c_f32_bf16_dpp v9, v33, v236 row_newbcast:8 row_mask:0xf bank_mask:0xf
v_dot2c_f32_bf16_dpp v10, v32, v237 row_newbcast:8 row_mask:0xf bank_mask:0xf
v_dot2c_f32_bf16_dpp v11, v33, v237 row_newbcast:8 row_mask:0xf bank_mask:0xf
v_dot2c_f32_bf16_dpp v12, v32, v238 row_newbcast:8 row_mask:0xf bank_mask:0xf
v_dot2c_f32_bf16_dpp v13, v33, v238 row_newbcast:8 row_mask:0xf bank_mask:0xf
v_dot2c_f32_bf16_dpp v14, v32, v239 row_newbcast:8 row_mask:0xf bank_mask:0xf
v_dot2c_f32_bf16_dpp v15, v33, v239 row_newbcast:8 row_mask:0xf bank_mask:0xf
v_dot2c_f32_bf16_dpp v8, v32, v240 row_newbcast:12 row_mask:0xf bank_mask:0xf
v_dot2c_f32_bf16_dpp v9, v33, v240 row_newbcast:12 row_mask:0xf bank_mask:0xf
v_dot2c_f32_bf16_dpp v10, v32, v241 row_newbcast:12 row_mask:0xf bank_mask:0xf
v_dot2c_f32_bf16_dpp v11, v33, v241 row_newbcast:12 row_mask:0xf bank_mask:0xf
v_dot2c_f32_bf16_dpp v12, v32, v242 row_newbcast:12 row_mask:0xf bank_mask:0xf
v_dot2c_f32_bf16_dpp v13, v33, v242 row_newbcast:12 row_mask:0xf bank_mask:0xf
v_dot2c_f32_bf16_dpp v14, v32, v243 row_newbcast:12 row_mask:0xf bank_mask:0xf
v_dot2c_f32_bf16_dpp v15, v33, v243 row_newbcast:12 row_mask:0xf bank_mask:0xf
s_mov_b32 s58, 524288
buffer_load_dwordx4 v[228:231], v2, s[28:31], s58 offen offset:0 nt
buffer_load_dwordx4 v[232:235], v2, s[28:31], s58 offen offset:1024 nt
buffer_load_dwordx4 v[236:239], v2, s[28:31], s58 offen offset:2048 nt
buffer_load_dwordx4 v[240:243], v2, s[28:31], s58 offen offset:3072 nt
s_waitcnt vmcnt(36)
v_dot2_f32_bf16 v22, v148, v4, 0
v_dot2_f32_bf16 v23, v152, v4, 0
v_dot2_f32_bf16 v24, v156, v4, 0
v_dot2_f32_bf16 v25, v160, v4, 0
v_dot2c_f32_bf16 v22, v149, v5
v_dot2c_f32_bf16 v23, v153, v5
v_dot2c_f32_bf16 v24, v157, v5
v_dot2c_f32_bf16 v25, v161, v5
v_dot2c_f32_bf16 v22, v150, v6
v_dot2c_f32_bf16 v23, v154, v6
v_dot2c_f32_bf16 v24, v158, v6
v_dot2c_f32_bf16 v25, v162, v6
v_dot2c_f32_bf16 v22, v151, v7
v_dot2c_f32_bf16 v23, v155, v7
v_dot2c_f32_bf16 v24, v159, v7
v_dot2c_f32_bf16 v25, v163, v7
s_mov_b32 s58, 589824
buffer_load_dwordx4 v[148:151], v2, s[24:27], s58 offen offset:0 nt
buffer_load_dwordx4 v[152:155], v2, s[24:27], s58 offen offset:1024 nt
buffer_load_dwordx4 v[156:159], v2, s[24:27], s58 offen offset:2048 nt
buffer_load_dwordx4 v[160:163], v2, s[24:27], s58 offen offset:3072 nt
v_add_f32_dpp v26, v22, v22 row_ror:8 row_mask:0xf bank_mask:0x3
v_add_f32_dpp v27, v23, v23 row_ror:8 row_mask:0xf bank_mask:0x3
s_nop 0
v_add_f32_dpp v26, v24, v24 row_ror:8 row_mask:0xf bank_mask:0xc
v_add_f32_dpp v27, v25, v25 row_ror:8 row_mask:0xf bank_mask:0xc
s_nop 0
v_add_f32_dpp v28, v26, v26 row_half_mirror row_mask:0xf bank_mask:0x5
s_nop 1
v_add_f32_dpp v28, v27, v27 row_half_mirror row_mask:0xf bank_mask:0xa
s_nop 1
v_add_f32_dpp v28, v28, v28 quad_perm:[1,0,3,2] row_mask:0xf bank_mask:0xf
s_nop 1
v_add_f32_dpp v28, v28, v28 quad_perm:[2,3,0,1] row_mask:0xf bank_mask:0xf
v_cvt_pk_bf16_f32 v28, v28, v28
v_and_b32 v28, s62, v28
v_mul_f32 v28, s60, v28
v_cvt_pk_bf16_f32 v28, v28, v28
v_and_b32 v28, s62, v28
s_nop 1
v_max_f32_dpp v29, v28, v28 row_ror:8 row_mask:0xf bank_mask:0xf
s_nop 1
v_max_f32_dpp v29, v29, v29 row_ror:4 row_mask:0xf bank_mask:0xf
v_max_f32 v29, v29, v16
v_sub_f32 v30, v16, v29
v_sub_f32 v31, v28, v29
v_mov_b32 v16, v29
v_mul_f32 v30, s61, v30
v_mul_f32 v31, s61, v31
v_exp_f32 v30, v30
v_exp_f32 v31, v31
s_nop 0
v_fma_f32 v17, v17, v30, v31
v_cvt_pk_bf16_f32 v32, v31, 0
v_cvt_pk_bf16_f32 v33, 0, v31
v_mul_f32 v8, v8, v30
v_mul_f32 v9, v9, v30
v_mul_f32 v10, v10, v30
v_mul_f32 v11, v11, v30
v_mul_f32 v12, v12, v30
v_mul_f32 v13, v13, v30
v_mul_f32 v14, v14, v30
v_mul_f32 v15, v15, v30
s_waitcnt vmcnt(36)
v_dot2c_f32_bf16_dpp v8, v32, v164 row_newbcast:0 row_mask:0xf bank_mask:0xf
v_dot2c_f32_bf16_dpp v9, v33, v164 row_newbcast:0 row_mask:0xf bank_mask:0xf
v_dot2c_f32_bf16_dpp v10, v32, v165 row_newbcast:0 row_mask:0xf bank_mask:0xf
v_dot2c_f32_bf16_dpp v11, v33, v165 row_newbcast:0 row_mask:0xf bank_mask:0xf
v_dot2c_f32_bf16_dpp v12, v32, v166 row_newbcast:0 row_mask:0xf bank_mask:0xf
v_dot2c_f32_bf16_dpp v13, v33, v166 row_newbcast:0 row_mask:0xf bank_mask:0xf
v_dot2c_f32_bf16_dpp v14, v32, v167 row_newbcast:0 row_mask:0xf bank_mask:0xf
v_dot2c_f32_bf16_dpp v15, v33, v167 row_newbcast:0 row_mask:0xf bank_mask:0xf
v_dot2c_f32_bf16_dpp v8, v32, v168 row_newbcast:4 row_mask:0xf bank_mask:0xf
v_dot2c_f32_bf16_dpp v9, v33, v168 row_newbcast:4 row_mask:0xf bank_mask:0xf
v_dot2c_f32_bf16_dpp v10, v32, v169 row_newbcast:4 row_mask:0xf bank_mask:0xf
v_dot2c_f32_bf16_dpp v11, v33, v169 row_newbcast:4 row_mask:0xf bank_mask:0xf
v_dot2c_f32_bf16_dpp v12, v32, v170 row_newbcast:4 row_mask:0xf bank_mask:0xf
v_dot2c_f32_bf16_dpp v13, v33, v170 row_newbcast:4 row_mask:0xf bank_mask:0xf
v_dot2c_f32_bf16_dpp v14, v32, v171 row_newbcast:4 row_mask:0xf bank_mask:0xf
v_dot2c_f32_bf16_dpp v15, v33, v171 row_newbcast:4 row_mask:0xf bank_mask:0xf
v_dot2c_f32_bf16_dpp v8, v32, v172 row_newbcast:8 row_mask:0xf bank_mask:0xf
v_dot2c_f32_bf16_dpp v9, v33, v172 row_newbcast:8 row_mask:0xf bank_mask:0xf
v_dot2c_f32_bf16_dpp v10, v32, v173 row_newbcast:8 row_mask:0xf bank_mask:0xf
v_dot2c_f32_bf16_dpp v11, v33, v173 row_newbcast:8 row_mask:0xf bank_mask:0xf
v_dot2c_f32_bf16_dpp v12, v32, v174 row_newbcast:8 row_mask:0xf bank_mask:0xf
v_dot2c_f32_bf16_dpp v13, v33, v174 row_newbcast:8 row_mask:0xf bank_mask:0xf
v_dot2c_f32_bf16_dpp v14, v32, v175 row_newbcast:8 row_mask:0xf bank_mask:0xf
v_dot2c_f32_bf16_dpp v15, v33, v175 row_newbcast:8 row_mask:0xf bank_mask:0xf
v_dot2c_f32_bf16_dpp v8, v32, v176 row_newbcast:12 row_mask:0xf bank_mask:0xf
v_dot2c_f32_bf16_dpp v9, v33, v176 row_newbcast:12 row_mask:0xf bank_mask:0xf
v_dot2c_f32_bf16_dpp v10, v32, v177 row_newbcast:12 row_mask:0xf bank_mask:0xf
v_dot2c_f32_bf16_dpp v11, v33, v177 row_newbcast:12 row_mask:0xf bank_mask:0xf
v_dot2c_f32_bf16_dpp v12, v32, v178 row_newbcast:12 row_mask:0xf bank_mask:0xf
v_dot2c_f32_bf16_dpp v13, v33, v178 row_newbcast:12 row_mask:0xf bank_mask:0xf
v_dot2c_f32_bf16_dpp v14, v32, v179 row_newbcast:12 row_mask:0xf bank_mask:0xf
v_dot2c_f32_bf16_dpp v15, v33, v179 row_newbcast:12 row_mask:0xf bank_mask:0xf
s_mov_b32 s58, 589824
buffer_load_dwordx4 v[164:167], v2, s[28:31], s58 offen offset:0 nt
buffer_load_dwordx4 v[168:171], v2, s[28:31], s58 offen offset:1024 nt
buffer_load_dwordx4 v[172:175], v2, s[28:31], s58 offen offset:2048 nt
buffer_load_dwordx4 v[176:179], v2, s[28:31], s58 offen offset:3072 nt
v_and_b32 v43, 7, v19
v_lshl_add_u32 v42, v18, 3, v43
v_lshlrev_b32 v42, 3, v42
v_mov_b32 v44, 0
L_fl_4:
ds_read_b32 v45, v44 offset:9608
s_waitcnt lgkmcnt(0)
v_readfirstlane_b32 s59, v45
s_cmp_ge_u32 s59, 4
s_cbranch_scc1 L_fl_4_ok
s_sleep 1
s_branch L_fl_4
L_fl_4_ok:
ds_read_b64 v[22:23], v42 offset:4096
ds_read_b64 v[24:25], v42 offset:4352
ds_read_b64 v[26:27], v42 offset:4608
ds_read_b64 v[28:29], v42 offset:4864
v_mov_b32 v34, 0
v_mov_b32 v35, 0
v_mov_b32 v36, 0
v_mov_b32 v37, 0
v_mov_b32 v38, 0
v_mov_b32 v39, 0
v_mov_b32 v40, 0
v_mov_b32 v41, 0
s_waitcnt lgkmcnt(0)
v_pk_add_f32 v[22:23], v[22:23], v[24:25]
v_pk_add_f32 v[26:27], v[26:27], v[28:29]
v_pk_add_f32 v[22:23], v[22:23], v[26:27]
v_cvt_pk_bf16_f32 v22, v22, v22
v_and_b32 v22, s62, v22
v_cvt_pk_bf16_f32 v23, v23, v23
v_and_b32 v23, s62, v23
v_mul_f32 v24, s61, v22
v_mul_f32 v25, s61, v23
v_exp_f32 v24, -v24
v_exp_f32 v25, -v25
v_add_f32 v24, 1.0, v24
v_add_f32 v25, 1.0, v25
v_rcp_f32 v24, v24
v_rcp_f32 v25, v25
v_mul_f32 v22, v22, v24
v_mul_f32 v23, v23, v25
v_cvt_pk_bf16_f32 v30, v22, 0
v_cvt_pk_bf16_f32 v31, 0, v22
v_cvt_pk_bf16_f32 v32, v23, 0
v_cvt_pk_bf16_f32 v33, 0, v23
s_waitcnt vmcnt(24)
v_dot2c_f32_bf16_dpp v34, v30, v48 row_newbcast:0 row_mask:0xf bank_mask:0xf
v_dot2c_f32_bf16_dpp v35, v31, v48 row_newbcast:0 row_mask:0xf bank_mask:0xf
v_dot2c_f32_bf16_dpp v36, v30, v49 row_newbcast:0 row_mask:0xf bank_mask:0xf
v_dot2c_f32_bf16_dpp v37, v31, v49 row_newbcast:0 row_mask:0xf bank_mask:0xf
v_dot2c_f32_bf16_dpp v38, v30, v50 row_newbcast:0 row_mask:0xf bank_mask:0xf
v_dot2c_f32_bf16_dpp v39, v31, v50 row_newbcast:0 row_mask:0xf bank_mask:0xf
v_dot2c_f32_bf16_dpp v40, v30, v51 row_newbcast:0 row_mask:0xf bank_mask:0xf
v_dot2c_f32_bf16_dpp v41, v31, v51 row_newbcast:0 row_mask:0xf bank_mask:0xf
v_dot2c_f32_bf16_dpp v34, v32, v52 row_newbcast:0 row_mask:0xf bank_mask:0xf
v_dot2c_f32_bf16_dpp v35, v33, v52 row_newbcast:0 row_mask:0xf bank_mask:0xf
v_dot2c_f32_bf16_dpp v36, v32, v53 row_newbcast:0 row_mask:0xf bank_mask:0xf
v_dot2c_f32_bf16_dpp v37, v33, v53 row_newbcast:0 row_mask:0xf bank_mask:0xf
v_dot2c_f32_bf16_dpp v38, v32, v54 row_newbcast:0 row_mask:0xf bank_mask:0xf
v_dot2c_f32_bf16_dpp v39, v33, v54 row_newbcast:0 row_mask:0xf bank_mask:0xf
v_dot2c_f32_bf16_dpp v40, v32, v55 row_newbcast:0 row_mask:0xf bank_mask:0xf
v_dot2c_f32_bf16_dpp v41, v33, v55 row_newbcast:0 row_mask:0xf bank_mask:0xf
v_dot2c_f32_bf16_dpp v34, v30, v56 row_newbcast:1 row_mask:0xf bank_mask:0xf
v_dot2c_f32_bf16_dpp v35, v31, v56 row_newbcast:1 row_mask:0xf bank_mask:0xf
v_dot2c_f32_bf16_dpp v36, v30, v57 row_newbcast:1 row_mask:0xf bank_mask:0xf
v_dot2c_f32_bf16_dpp v37, v31, v57 row_newbcast:1 row_mask:0xf bank_mask:0xf
v_dot2c_f32_bf16_dpp v38, v30, v58 row_newbcast:1 row_mask:0xf bank_mask:0xf
v_dot2c_f32_bf16_dpp v39, v31, v58 row_newbcast:1 row_mask:0xf bank_mask:0xf
v_dot2c_f32_bf16_dpp v40, v30, v59 row_newbcast:1 row_mask:0xf bank_mask:0xf
v_dot2c_f32_bf16_dpp v41, v31, v59 row_newbcast:1 row_mask:0xf bank_mask:0xf
v_dot2c_f32_bf16_dpp v34, v32, v60 row_newbcast:1 row_mask:0xf bank_mask:0xf
v_dot2c_f32_bf16_dpp v35, v33, v60 row_newbcast:1 row_mask:0xf bank_mask:0xf
v_dot2c_f32_bf16_dpp v36, v32, v61 row_newbcast:1 row_mask:0xf bank_mask:0xf
v_dot2c_f32_bf16_dpp v37, v33, v61 row_newbcast:1 row_mask:0xf bank_mask:0xf
v_dot2c_f32_bf16_dpp v38, v32, v62 row_newbcast:1 row_mask:0xf bank_mask:0xf
v_dot2c_f32_bf16_dpp v39, v33, v62 row_newbcast:1 row_mask:0xf bank_mask:0xf
v_dot2c_f32_bf16_dpp v40, v32, v63 row_newbcast:1 row_mask:0xf bank_mask:0xf
v_dot2c_f32_bf16_dpp v41, v33, v63 row_newbcast:1 row_mask:0xf bank_mask:0xf
v_dot2c_f32_bf16_dpp v34, v30, v64 row_newbcast:2 row_mask:0xf bank_mask:0xf
v_dot2c_f32_bf16_dpp v35, v31, v64 row_newbcast:2 row_mask:0xf bank_mask:0xf
v_dot2c_f32_bf16_dpp v36, v30, v65 row_newbcast:2 row_mask:0xf bank_mask:0xf
v_dot2c_f32_bf16_dpp v37, v31, v65 row_newbcast:2 row_mask:0xf bank_mask:0xf
v_dot2c_f32_bf16_dpp v38, v30, v66 row_newbcast:2 row_mask:0xf bank_mask:0xf
v_dot2c_f32_bf16_dpp v39, v31, v66 row_newbcast:2 row_mask:0xf bank_mask:0xf
v_dot2c_f32_bf16_dpp v40, v30, v67 row_newbcast:2 row_mask:0xf bank_mask:0xf
v_dot2c_f32_bf16_dpp v41, v31, v67 row_newbcast:2 row_mask:0xf bank_mask:0xf
v_dot2c_f32_bf16_dpp v34, v32, v68 row_newbcast:2 row_mask:0xf bank_mask:0xf
v_dot2c_f32_bf16_dpp v35, v33, v68 row_newbcast:2 row_mask:0xf bank_mask:0xf
v_dot2c_f32_bf16_dpp v36, v32, v69 row_newbcast:2 row_mask:0xf bank_mask:0xf
v_dot2c_f32_bf16_dpp v37, v33, v69 row_newbcast:2 row_mask:0xf bank_mask:0xf
v_dot2c_f32_bf16_dpp v38, v32, v70 row_newbcast:2 row_mask:0xf bank_mask:0xf
v_dot2c_f32_bf16_dpp v39, v33, v70 row_newbcast:2 row_mask:0xf bank_mask:0xf
v_dot2c_f32_bf16_dpp v40, v32, v71 row_newbcast:2 row_mask:0xf bank_mask:0xf
v_dot2c_f32_bf16_dpp v41, v33, v71 row_newbcast:2 row_mask:0xf bank_mask:0xf
v_dot2c_f32_bf16_dpp v34, v30, v72 row_newbcast:3 row_mask:0xf bank_mask:0xf
v_dot2c_f32_bf16_dpp v35, v31, v72 row_newbcast:3 row_mask:0xf bank_mask:0xf
v_dot2c_f32_bf16_dpp v36, v30, v73 row_newbcast:3 row_mask:0xf bank_mask:0xf
v_dot2c_f32_bf16_dpp v37, v31, v73 row_newbcast:3 row_mask:0xf bank_mask:0xf
v_dot2c_f32_bf16_dpp v38, v30, v74 row_newbcast:3 row_mask:0xf bank_mask:0xf
v_dot2c_f32_bf16_dpp v39, v31, v74 row_newbcast:3 row_mask:0xf bank_mask:0xf
v_dot2c_f32_bf16_dpp v40, v30, v75 row_newbcast:3 row_mask:0xf bank_mask:0xf
v_dot2c_f32_bf16_dpp v41, v31, v75 row_newbcast:3 row_mask:0xf bank_mask:0xf
v_dot2c_f32_bf16_dpp v34, v32, v76 row_newbcast:3 row_mask:0xf bank_mask:0xf
v_dot2c_f32_bf16_dpp v35, v33, v76 row_newbcast:3 row_mask:0xf bank_mask:0xf
v_dot2c_f32_bf16_dpp v36, v32, v77 row_newbcast:3 row_mask:0xf bank_mask:0xf
v_dot2c_f32_bf16_dpp v37, v33, v77 row_newbcast:3 row_mask:0xf bank_mask:0xf
v_dot2c_f32_bf16_dpp v38, v32, v78 row_newbcast:3 row_mask:0xf bank_mask:0xf
v_dot2c_f32_bf16_dpp v39, v33, v78 row_newbcast:3 row_mask:0xf bank_mask:0xf
v_dot2c_f32_bf16_dpp v40, v32, v79 row_newbcast:3 row_mask:0xf bank_mask:0xf
v_dot2c_f32_bf16_dpp v41, v33, v79 row_newbcast:3 row_mask:0xf bank_mask:0xf
v_dot2c_f32_bf16_dpp v34, v30, v80 row_newbcast:4 row_mask:0xf bank_mask:0xf
v_dot2c_f32_bf16_dpp v35, v31, v80 row_newbcast:4 row_mask:0xf bank_mask:0xf
v_dot2c_f32_bf16_dpp v36, v30, v81 row_newbcast:4 row_mask:0xf bank_mask:0xf
v_dot2c_f32_bf16_dpp v37, v31, v81 row_newbcast:4 row_mask:0xf bank_mask:0xf
v_dot2c_f32_bf16_dpp v38, v30, v82 row_newbcast:4 row_mask:0xf bank_mask:0xf
v_dot2c_f32_bf16_dpp v39, v31, v82 row_newbcast:4 row_mask:0xf bank_mask:0xf
v_dot2c_f32_bf16_dpp v40, v30, v83 row_newbcast:4 row_mask:0xf bank_mask:0xf
v_dot2c_f32_bf16_dpp v41, v31, v83 row_newbcast:4 row_mask:0xf bank_mask:0xf
v_dot2c_f32_bf16_dpp v34, v32, v84 row_newbcast:4 row_mask:0xf bank_mask:0xf
v_dot2c_f32_bf16_dpp v35, v33, v84 row_newbcast:4 row_mask:0xf bank_mask:0xf
v_dot2c_f32_bf16_dpp v36, v32, v85 row_newbcast:4 row_mask:0xf bank_mask:0xf
v_dot2c_f32_bf16_dpp v37, v33, v85 row_newbcast:4 row_mask:0xf bank_mask:0xf
v_dot2c_f32_bf16_dpp v38, v32, v86 row_newbcast:4 row_mask:0xf bank_mask:0xf
v_dot2c_f32_bf16_dpp v39, v33, v86 row_newbcast:4 row_mask:0xf bank_mask:0xf
v_dot2c_f32_bf16_dpp v40, v32, v87 row_newbcast:4 row_mask:0xf bank_mask:0xf
v_dot2c_f32_bf16_dpp v41, v33, v87 row_newbcast:4 row_mask:0xf bank_mask:0xf
v_dot2c_f32_bf16_dpp v34, v30, v88 row_newbcast:5 row_mask:0xf bank_mask:0xf
v_dot2c_f32_bf16_dpp v35, v31, v88 row_newbcast:5 row_mask:0xf bank_mask:0xf
v_dot2c_f32_bf16_dpp v36, v30, v89 row_newbcast:5 row_mask:0xf bank_mask:0xf
v_dot2c_f32_bf16_dpp v37, v31, v89 row_newbcast:5 row_mask:0xf bank_mask:0xf
v_dot2c_f32_bf16_dpp v38, v30, v90 row_newbcast:5 row_mask:0xf bank_mask:0xf
v_dot2c_f32_bf16_dpp v39, v31, v90 row_newbcast:5 row_mask:0xf bank_mask:0xf
v_dot2c_f32_bf16_dpp v40, v30, v91 row_newbcast:5 row_mask:0xf bank_mask:0xf
v_dot2c_f32_bf16_dpp v41, v31, v91 row_newbcast:5 row_mask:0xf bank_mask:0xf
v_dot2c_f32_bf16_dpp v34, v32, v92 row_newbcast:5 row_mask:0xf bank_mask:0xf
v_dot2c_f32_bf16_dpp v35, v33, v92 row_newbcast:5 row_mask:0xf bank_mask:0xf
v_dot2c_f32_bf16_dpp v36, v32, v93 row_newbcast:5 row_mask:0xf bank_mask:0xf
v_dot2c_f32_bf16_dpp v37, v33, v93 row_newbcast:5 row_mask:0xf bank_mask:0xf
v_dot2c_f32_bf16_dpp v38, v32, v94 row_newbcast:5 row_mask:0xf bank_mask:0xf
v_dot2c_f32_bf16_dpp v39, v33, v94 row_newbcast:5 row_mask:0xf bank_mask:0xf
v_dot2c_f32_bf16_dpp v40, v32, v95 row_newbcast:5 row_mask:0xf bank_mask:0xf
v_dot2c_f32_bf16_dpp v41, v33, v95 row_newbcast:5 row_mask:0xf bank_mask:0xf
v_dot2c_f32_bf16_dpp v34, v30, v96 row_newbcast:6 row_mask:0xf bank_mask:0xf
v_dot2c_f32_bf16_dpp v35, v31, v96 row_newbcast:6 row_mask:0xf bank_mask:0xf
v_dot2c_f32_bf16_dpp v36, v30, v97 row_newbcast:6 row_mask:0xf bank_mask:0xf
v_dot2c_f32_bf16_dpp v37, v31, v97 row_newbcast:6 row_mask:0xf bank_mask:0xf
v_dot2c_f32_bf16_dpp v38, v30, v98 row_newbcast:6 row_mask:0xf bank_mask:0xf
v_dot2c_f32_bf16_dpp v39, v31, v98 row_newbcast:6 row_mask:0xf bank_mask:0xf
v_dot2c_f32_bf16_dpp v40, v30, v99 row_newbcast:6 row_mask:0xf bank_mask:0xf
v_dot2c_f32_bf16_dpp v41, v31, v99 row_newbcast:6 row_mask:0xf bank_mask:0xf
v_dot2c_f32_bf16_dpp v34, v32, v100 row_newbcast:6 row_mask:0xf bank_mask:0xf
v_dot2c_f32_bf16_dpp v35, v33, v100 row_newbcast:6 row_mask:0xf bank_mask:0xf
v_dot2c_f32_bf16_dpp v36, v32, v101 row_newbcast:6 row_mask:0xf bank_mask:0xf
v_dot2c_f32_bf16_dpp v37, v33, v101 row_newbcast:6 row_mask:0xf bank_mask:0xf
v_dot2c_f32_bf16_dpp v38, v32, v102 row_newbcast:6 row_mask:0xf bank_mask:0xf
v_dot2c_f32_bf16_dpp v39, v33, v102 row_newbcast:6 row_mask:0xf bank_mask:0xf
v_dot2c_f32_bf16_dpp v40, v32, v103 row_newbcast:6 row_mask:0xf bank_mask:0xf
v_dot2c_f32_bf16_dpp v41, v33, v103 row_newbcast:6 row_mask:0xf bank_mask:0xf
v_dot2c_f32_bf16_dpp v34, v30, v104 row_newbcast:7 row_mask:0xf bank_mask:0xf
v_dot2c_f32_bf16_dpp v35, v31, v104 row_newbcast:7 row_mask:0xf bank_mask:0xf
v_dot2c_f32_bf16_dpp v36, v30, v105 row_newbcast:7 row_mask:0xf bank_mask:0xf
v_dot2c_f32_bf16_dpp v37, v31, v105 row_newbcast:7 row_mask:0xf bank_mask:0xf
v_dot2c_f32_bf16_dpp v38, v30, v106 row_newbcast:7 row_mask:0xf bank_mask:0xf
v_dot2c_f32_bf16_dpp v39, v31, v106 row_newbcast:7 row_mask:0xf bank_mask:0xf
v_dot2c_f32_bf16_dpp v40, v30, v107 row_newbcast:7 row_mask:0xf bank_mask:0xf
v_dot2c_f32_bf16_dpp v41, v31, v107 row_newbcast:7 row_mask:0xf bank_mask:0xf
v_dot2c_f32_bf16_dpp v34, v32, v108 row_newbcast:7 row_mask:0xf bank_mask:0xf
v_dot2c_f32_bf16_dpp v35, v33, v108 row_newbcast:7 row_mask:0xf bank_mask:0xf
v_dot2c_f32_bf16_dpp v36, v32, v109 row_newbcast:7 row_mask:0xf bank_mask:0xf
v_dot2c_f32_bf16_dpp v37, v33, v109 row_newbcast:7 row_mask:0xf bank_mask:0xf
v_dot2c_f32_bf16_dpp v38, v32, v110 row_newbcast:7 row_mask:0xf bank_mask:0xf
v_dot2c_f32_bf16_dpp v39, v33, v110 row_newbcast:7 row_mask:0xf bank_mask:0xf
v_dot2c_f32_bf16_dpp v40, v32, v111 row_newbcast:7 row_mask:0xf bank_mask:0xf
v_dot2c_f32_bf16_dpp v41, v33, v111 row_newbcast:7 row_mask:0xf bank_mask:0xf
v_permlane32_swap_b32 v34, v38
v_permlane32_swap_b32 v35, v39
v_permlane32_swap_b32 v36, v40
v_permlane32_swap_b32 v37, v41
v_add_f32 v34, v34, v38
v_add_f32 v35, v35, v39
v_add_f32 v36, v36, v40
v_add_f32 v37, v37, v41
s_nop 0
v_permlane16_swap_b32 v34, v36
v_permlane16_swap_b32 v35, v37
v_add_f32 v34, v34, v36
v_add_f32 v35, v35, v37
s_lshl_b32 s59, s53, 6
s_add_u32 s59, s59, s56
s_lshl_b32 s59, s59, 12
s_lshl_b32 s65, s48, 10
s_add_u32 s59, s59, s65
s_add_u32 s59, s59, 2097152
v_lshlrev_b32 v136, 1, v20
v_add_u32 v136, s59, v136
v_mov_b32 v132, v34
v_mov_b32 v133, v35
v_mov_b32 v134, 0
v_mov_b32 v135, s63
s_branch L_join
L_fpath:
s_cmp_lg_u32 s48, 4
s_cbranch_scc1 L_f_noln
v_mov_b32 v30, 0
v_mov_b32 v31, 0
v_mov_b32 v32, 0
v_mov_b32 v33, 0
v_mov_b32 v34, 0
ds_write_b128 v34, v[30:33] offset:9600
ds_write_b128 v34, v[30:33] offset:9616
v_lshlrev_b32 v22, 4, v1
s_lshl_b32 s59, s53, 10
v_add_u32 v22, s59, v22
s_waitcnt lgkmcnt(0)
global_load_dwordx4 v[12:15], v22, s[4:5]
s_barrier
s_mov_b32 s24, s6
s_mov_b32 s25, s7
s_mov_b32 s26, 0x8000000
s_mov_b32 s27, 0x20000
s_mov_b32 s28, s8
s_mov_b32 s29, s9
s_mov_b32 s30, 0x8000000
s_mov_b32 s31, 0x20000
s_lshl_b32 s59, s53, 5
s_add_u32 s59, s59, s54
s_lshl_b32 s59, s59, 20
s_lshl_b32 s65, s51, 15
s_add_u32 s59, s59, s65
s_lshl_b32 s65, s48, 12
s_add_u32 s59, s59, s65
v_lshlrev_b32 v29, 4, v1
v_add_u32 v2, s59, v29
s_and_b32 s55, s50, 7
s_lshl_b32 s56, s49, 3
s_add_u32 s56, s56, s55
s_lshr_b32 s57, s49, 1
s_mul_i32 s57, s57, 7
s_add_u32 s57, s57, s55
s_and_b32 s66, s48, 3
s_lshl_b32 s65, s53, 8
s_load_dword s64, s[22:23], s65
v_lshrrev_b32 v113, 3, v19
v_lshl_add_u32 v113, v113, 2, v18
s_lshl_b32 s59, s66, 7
v_add_u32 v113, s59, v113
v_mul_u32_u24 v113, 3584, v113
v_and_b32 v29, 7, v19
v_lshl_add_u32 v113, v29, 4, v113
s_lshl_b32 s59, s57, 7
v_add_u32 v113, s59, v113
s_lshl_b32 s59, s57, 16
s_lshl_b32 s65, s48, 8
s_add_u32 s59, s59, s65
v_lshlrev_b32 v114, 14, v18
v_lshl_add_u32 v114, v19, 4, v114
v_add_u32 v114, s59, v114
s_lshl_b32 s59, s54, 17
s_lshl_b32 s65, s48, 7
s_add_u32 s59, s59, s65
v_lshlrev_b32 v21, 15, v18
v_lshl_add_u32 v21, v19, 3, v21
v_add_u32 v21, s59, v21
v_lshl_add_u32 v20, v19, 2, v18
v_lshlrev_b32 v20, 3, v20
s_lshl_b32 s59, s53, 6
s_add_u32 s59, s59, s56
s_lshl_b32 s59, s59, 12
s_lshl_b32 s65, s48, 9
s_add_u32 s59, s59, s65
v_lshrrev_b32 v115, 1, v18
v_lshl_add_u32 v115, v19, 1, v115
v_lshlrev_b32 v115, 4, v115
v_add_u32 v115, s59, v115
s_mov_b32 s60, 0x3db504f3
s_mov_b32 s61, 0x3fb8aa3b
s_mov_b32 s68, 0x05040100
s_mov_b32 s69, 0x07060302
s_mov_b32 s36, s12
s_mov_b32 s37, s13
s_mov_b32 s38, 0x400000
s_mov_b32 s39, 0x20000
s_mov_b32 s40, s16
s_mov_b32 s41, s17
s_mov_b32 s42, 0x1c0000
s_mov_b32 s43, 0x20000
s_mov_b32 s44, s18
s_mov_b32 s45, s19
s_mov_b32 s46, 0x1c0000
s_mov_b32 s47, 0x20000
s_cmp_eq_u32 s55, 7
s_cselect_b32 s42, 0, s42
s_cselect_b32 s46, 0, s46
s_waitcnt vmcnt(0)
v_lshlrev_b32 v28, 16, v12
v_and_b32 v29, s62, v12
v_lshlrev_b32 v30, 16, v13
v_and_b32 v31, s62, v13
v_lshlrev_b32 v32, 16, v14
v_and_b32 v33, s62, v14
v_lshlrev_b32 v34, 16, v15
v_and_b32 v35, s62, v15
v_add_f32 v36, v28, v29
v_add_f32 v36, v36, v30
v_add_f32 v36, v36, v31
v_add_f32 v36, v36, v32
v_add_f32 v36, v36, v33
v_add_f32 v36, v36, v34
v_add_f32 v36, v36, v35
s_nop 1
v_add_f32_dpp v36, v36, v36 quad_perm:[1,0,3,2] row_mask:0xf bank_mask:0xf
s_nop 1
v_add_f32_dpp v36, v36, v36 quad_perm:[2,3,0,1] row_mask:0xf bank_mask:0xf
s_nop 1
v_add_f32_dpp v36, v36, v36 row_half_mirror row_mask:0xf bank_mask:0xf
s_nop 1
v_add_f32_dpp v36, v36, v36 row_mirror row_mask:0xf bank_mask:0xf
v_mov_b32 v37, v36
s_nop 1
v_permlane16_swap_b32 v36, v37
v_add_f32 v36, v36, v37
v_mov_b32 v37, v36
s_nop 1
v_permlane32_swap_b32 v36, v37
v_add_f32 v36, v36, v37
v_mul_f32 v36, 0x3b000000, v36
v_sub_f32 v38, v28, v36
v_mul_f32 v37, v38, v38
v_sub_f32 v38, v29, v36
v_fmac_f32 v37, v38, v38
v_sub_f32 v38, v30, v36
v_fmac_f32 v37, v38, v38
v_sub_f32 v38, v31, v36
v_fmac_f32 v37, v38, v38
v_sub_f32 v38, v32, v36
v_fmac_f32 v37, v38, v38
v_sub_f32 v38, v33, v36
v_fmac_f32 v37, v38, v38
v_sub_f32 v38, v34, v36
v_fmac_f32 v37, v38, v38
v_sub_f32 v38, v35, v36
v_fmac_f32 v37, v38, v38
s_nop 1
v_add_f32_dpp v37, v37, v37 quad_perm:[1,0,3,2] row_mask:0xf bank_mask:0xf
s_nop 1
v_add_f32_dpp v37, v37, v37 quad_perm:[2,3,0,1] row_mask:0xf bank_mask:0xf
s_nop 1
v_add_f32_dpp v37, v37, v37 row_half_mirror row_mask:0xf bank_mask:0xf
s_nop 1
v_add_f32_dpp v37, v37, v37 row_mirror row_mask:0xf bank_mask:0xf
v_mov_b32 v38, v37
s_nop 1
v_permlane16_swap_b32 v37, v38
v_add_f32 v37, v37, v38
v_mov_b32 v38, v37
s_nop 1
v_permlane32_swap_b32 v37, v38
v_add_f32 v37, v37, v38
v_mul_f32 v37, 0x3b000000, v37
v_cvt_pk_bf16_f32 v36, v36, v36
v_and_b32 v36, s62, v36
v_cvt_pk_bf16_f32 v37, v37, v37
v_and_b32 v37, s62, v37
v_add_f32 v37, 0x3727c5ac, v37
v_cvt_pk_bf16_f32 v37, v37, v37
v_and_b32 v37, s62, v37
v_sqrt_f32 v37, v37
s_nop 0
v_cvt_pk_bf16_f32 v37, v37, v37
v_and_b32 v37, s62, v37
v_rcp_f32 v38, v37
v_sub_f32 v28, v28, v36
v_sub_f32 v29, v29, v36
v_sub_f32 v30, v30, v36
v_sub_f32 v31, v31, v36
v_sub_f32 v32, v32, v36
v_sub_f32 v33, v33, v36
v_sub_f32 v34, v34, v36
v_sub_f32 v35, v35, v36
v_cvt_pk_bf16_f32 v39, v28, v29
v_lshlrev_b32 v28, 16, v39
v_and_b32 v29, s62, v39
v_cvt_pk_bf16_f32 v39, v30, v31
v_lshlrev_b32 v30, 16, v39
v_and_b32 v31, s62, v39
v_cvt_pk_bf16_f32 v39, v32, v33
v_lshlrev_b32 v32, 16, v39
v_and_b32 v33, s62, v39
v_cvt_pk_bf16_f32 v39, v34, v35
v_lshlrev_b32 v34, 16, v39
v_and_b32 v35, s62, v39
v_mul_f32 v8, v28, v38
v_fma_f32 v39, -v8, v37, v28
v_fma_f32 v8, v39, v38, v8
v_cvt_pk_bf16_f32 v8, v8, 0
v_mul_f32 v9, v29, v38
v_fma_f32 v39, -v9, v37, v29
v_fma_f32 v9, v39, v38, v9
v_cvt_pk_bf16_f32 v9, v9, 0
v_mul_f32 v10, v30, v38
v_fma_f32 v39, -v10, v37, v30
v_fma_f32 v10, v39, v38, v10
v_cvt_pk_bf16_f32 v10, v10, 0
v_mul_f32 v11, v31, v38
v_fma_f32 v39, -v11, v37, v31
v_fma_f32 v11, v39, v38, v11
v_cvt_pk_bf16_f32 v11, v11, 0
v_mul_f32 v12, v32, v38
v_fma_f32 v39, -v12, v37, v32
v_fma_f32 v12, v39, v38, v12
v_cvt_pk_bf16_f32 v12, v12, 0
v_mul_f32 v13, v33, v38
v_fma_f32 v39, -v13, v37, v33
v_fma_f32 v13, v39, v38, v13
v_cvt_pk_bf16_f32 v13, v13, 0
v_mul_f32 v14, v34, v38
v_fma_f32 v39, -v14, v37, v34
v_fma_f32 v14, v39, v38, v14
v_cvt_pk_bf16_f32 v14, v14, 0
v_mul_f32 v15, v35, v38
v_fma_f32 v39, -v15, v37, v35
v_fma_f32 v15, v39, v38, v15
v_cvt_pk_bf16_f32 v15, v15, 0
v_lshlrev_b32 v36, 5, v1
ds_write_b128 v36, v[8:11] offset:0
ds_write_b128 v36, v[12:15] offset:16
v_mov_b32 v38, 0
v_mov_b32 v39, 1
s_waitcnt lgkmcnt(0)
s_mov_b64 exec, 1
ds_add_u32 v38, v39 offset:9600
s_mov_b64 exec, -1
s_branch L_f_go
L_f_noln:
s_waitcnt lgkmcnt(0)
s_barrier
s_mov_b32 s24, s6
s_mov_b32 s25, s7
s_mov_b32 s26, 0x8000000
s_mov_b32 s27, 0x20000
s_mov_b32 s28, s8
s_mov_b32 s29, s9
s_mov_b32 s30, 0x8000000
s_mov_b32 s31, 0x20000
s_lshl_b32 s59, s53, 5
s_add_u32 s59, s59, s54
s_lshl_b32 s59, s59, 20
s_lshl_b32 s65, s51, 15
s_add_u32 s59, s59, s65
s_lshl_b32 s65, s48, 12
s_add_u32 s59, s59, s65
v_lshlrev_b32 v29, 4, v1
v_add_u32 v2, s59, v29
s_and_b32 s55, s50, 7
s_lshl_b32 s56, s49, 3
s_add_u32 s56, s56, s55
s_lshr_b32 s57, s49, 1
s_mul_i32 s57, s57, 7
s_add_u32 s57, s57, s55
s_and_b32 s66, s48, 3
s_lshl_b32 s65, s53, 8
s_load_dword s64, s[22:23], s65
v_lshrrev_b32 v113, 3, v19
v_lshl_add_u32 v113, v113, 2, v18
s_lshl_b32 s59, s66, 7
v_add_u32 v113, s59, v113
v_mul_u32_u24 v113, 3584, v113
v_and_b32 v29, 7, v19
v_lshl_add_u32 v113, v29, 4, v113
s_lshl_b32 s59, s57, 7
v_add_u32 v113, s59, v113
s_lshl_b32 s59, s57, 16
s_lshl_b32 s65, s48, 8
s_add_u32 s59, s59, s65
v_lshlrev_b32 v114, 14, v18
v_lshl_add_u32 v114, v19, 4, v114
v_add_u32 v114, s59, v114
s_lshl_b32 s59, s54, 17
s_lshl_b32 s65, s48, 7
s_add_u32 s59, s59, s65
v_lshlrev_b32 v21, 15, v18
v_lshl_add_u32 v21, v19, 3, v21
v_add_u32 v21, s59, v21
v_lshl_add_u32 v20, v19, 2, v18
v_lshlrev_b32 v20, 3, v20
s_lshl_b32 s59, s53, 6
s_add_u32 s59, s59, s56
s_lshl_b32 s59, s59, 12
s_lshl_b32 s65, s48, 9
s_add_u32 s59, s59, s65
v_lshrrev_b32 v115, 1, v18
v_lshl_add_u32 v115, v19, 1, v115
v_lshlrev_b32 v115, 4, v115
v_add_u32 v115, s59, v115
s_mov_b32 s60, 0x3db504f3
s_mov_b32 s61, 0x3fb8aa3b
s_mov_b32 s68, 0x05040100
s_mov_b32 s69, 0x07060302
s_mov_b32 s36, s12
s_mov_b32 s37, s13
s_mov_b32 s38, 0x400000
s_mov_b32 s39, 0x20000
s_mov_b32 s40, s16
s_mov_b32 s41, s17
s_mov_b32 s42, 0x1c0000
s_mov_b32 s43, 0x20000
s_mov_b32 s44, s18
s_mov_b32 s45, s19
s_mov_b32 s46, 0x1c0000
s_mov_b32 s47, 0x20000
s_cmp_eq_u32 s55, 7
s_cselect_b32 s42, 0, s42
s_cselect_b32 s46, 0, s46
L_f_go:
v_mov_b32 v38, 0
L_fl_5:
ds_read_b32 v39, v38 offset:9612
s_waitcnt lgkmcnt(0)
v_readfirstlane_b32 s59, v39
s_cmp_ge_u32 s59, 4
s_cbranch_scc1 L_fl_5_ok
s_sleep 1
s_branch L_fl_5
L_fl_5_ok:
s_cmp_lg_u32 s48, 5
s_cbranch_scc1 L_par_done
v_mov_b32 v22, 0
s_mov_b32 s67, 0
global_load_dword v23, v22, s[14:15]
s_waitcnt vmcnt(0)
v_readfirstlane_b32 s59, v23
s_cmp_lg_u32 s59, 0
s_cbranch_scc1 L_par_got
L_par_poll:
global_load_dword v23, v22, s[14:15] sc1
s_waitcnt vmcnt(0)
v_readfirstlane_b32 s59, v23
s_cmp_lg_u32 s59, 0
s_cbranch_scc1 L_par_got
s_add_u32 s67, s67, 1
s_cmp_lt_u32 s67, 20000
s_cbranch_scc1 L_par_poll
L_par_got:
s_sub_u32 s59, s59, 1
v_mov_b32 v23, s59
ds_write_b32 v22, v23 offset:9616
v_mov_b32 v24, 0
v_mov_b32 v25, 1
s_waitcnt lgkmcnt(0)
s_mov_b64 exec, 1
ds_add_u32 v24, v25 offset:9620
s_mov_b64 exec, -1
L_par_done:
s_mov_b32 s58, 0
buffer_load_dwordx4 v[180:183], v2, s[24:27], s58 offen offset:0 nt
buffer_load_dwordx4 v[184:187], v2, s[24:27], s58 offen offset:1024 nt
buffer_load_dwordx4 v[188:191], v2, s[24:27], s58 offen offset:2048 nt
buffer_load_dwordx4 v[192:195], v2, s[24:27], s58 offen offset:3072 nt
s_mov_b32 s58, 0
buffer_load_dwordx4 v[196:199], v2, s[28:31], s58 offen offset:0 nt
buffer_load_dwordx4 v[200:203], v2, s[28:31], s58 offen offset:1024 nt
buffer_load_dwordx4 v[204:207], v2, s[28:31], s58 offen offset:2048 nt
buffer_load_dwordx4 v[208:211], v2, s[28:31], s58 offen offset:3072 nt
s_mov_b32 s58, 65536
buffer_load_dwordx4 v[212:215], v2, s[24:27], s58 offen offset:0 nt
buffer_load_dwordx4 v[216:219], v2, s[24:27], s58 offen offset:1024 nt
buffer_load_dwordx4 v[220:223], v2, s[24:27], s58 offen offset:2048 nt
buffer_load_dwordx4 v[224:227], v2, s[24:27], s58 offen offset:3072 nt
s_mov_b32 s58, 65536
buffer_load_dwordx4 v[228:231], v2, s[28:31], s58 offen offset:0 nt
buffer_load_dwordx4 v[232:235], v2, s[28:31], s58 offen offset:1024 nt
buffer_load_dwordx4 v[236:239], v2, s[28:31], s58 offen offset:2048 nt
buffer_load_dwordx4 v[240:243], v2, s[28:31], s58 offen offset:3072 nt
s_mov_b32 s58, 131072
buffer_load_dwordx4 v[148:151], v2, s[24:27], s58 offen offset:0 nt
buffer_load_dwordx4 v[152:155], v2, s[24:27], s58 offen offset:1024 nt
buffer_load_dwordx4 v[156:159], v2, s[24:27], s58 offen offset:2048 nt
buffer_load_dwordx4 v[160:163], v2, s[24:27], s58 offen offset:3072 nt
s_mov_b32 s58, 131072
buffer_load_dwordx4 v[164:167], v2, s[28:31], s58 offen offset:0 nt
buffer_load_dwordx4 v[168:171], v2, s[28:31], s58 offen offset:1024 nt
buffer_load_dwordx4 v[172:175], v2, s[28:31], s58 offen offset:2048 nt
buffer_load_dwordx4 v[176:179], v2, s[28:31], s58 offen offset:3072 nt
s_mov_b32 s58, 196608
buffer_load_dwordx4 v[48:51], v2, s[24:27], s58 offen offset:0 nt
buffer_load_dwordx4 v[52:55], v2, s[24:27], s58 offen offset:1024 nt
buffer_load_dwordx4 v[56:59], v2, s[24:27], s58 offen offset:2048 nt
buffer_load_dwordx4 v[60:63], v2, s[24:27], s58 offen offset:3072 nt
s_mov_b32 s58, 196608
buffer_load_dwordx4 v[64:67], v2, s[28:31], s58 offen offset:0 nt
buffer_load_dwordx4 v[68:71], v2, s[28:31], s58 offen offset:1024 nt
buffer_load_dwordx4 v[72:75], v2, s[28:31], s58 offen offset:2048 nt
buffer_load_dwordx4 v[76:79], v2, s[28:31], s58 offen offset:3072 nt
v_mov_b32 v38, 0
L_fl_6:
ds_read_b32 v39, v38 offset:9604
s_waitcnt lgkmcnt(0)
v_readfirstlane_b32 s59, v39
s_cmp_ge_u32 s59, 4
s_cbranch_scc1 L_fl_6_ok
s_sleep 2
s_branch L_fl_6
L_fl_6_ok:
ds_read_b64 v[40:41], v20 offset:2048
ds_read_b64 v[42:43], v20 offset:2560
ds_read_b64 v[44:45], v20 offset:3072
ds_read_b64 v[46:47], v20 offset:3584
s_waitcnt lgkmcnt(0)
v_pk_add_f32 v[40:41], v[40:41], v[42:43]
v_pk_add_f32 v[44:45], v[44:45], v[46:47]
v_pk_add_f32 v[40:41], v[40:41], v[44:45]
v_cvt_pk_bf16_f32 v4, v40, v41
v_mov_b32 v5, v4
s_nop 1
v_permlane16_swap_b32 v4, v5
v_mov_b32 v6, v4
v_mov_b32 v7, v5
s_nop 0
v_permlane32_swap_b32 v4, v6
v_permlane32_swap_b32 v5, v7
v_mov_b32 v8, 0
v_mov_b32 v9, 0
v_mov_b32 v10, 0
v_mov_b32 v11, 0
v_mov_b32 v12, 0
v_mov_b32 v13, 0
v_mov_b32 v14, 0
v_mov_b32 v15, 0
v_mov_b32 v16, 0xff7fffff
v_mov_b32 v17, 0
s_mul_i32 s63, s64, 0x9e3779b1
s_add_u32 s63, s63, 0x7f4a7c15
v_mov_b32 v136, v115
s_waitcnt vmcnt(28)
v_dot2_f32_bf16 v22, v180, v4, 0
v_dot2_f32_bf16 v23, v184, v4, 0
v_dot2_f32_bf16 v24, v188, v4, 0
v_dot2_f32_bf16 v25, v192, v4, 0
v_dot2c_f32_bf16 v22, v181, v5
v_dot2c_f32_bf16 v23, v185, v5
v_dot2c_f32_bf16 v24, v189, v5
v_dot2c_f32_bf16 v25, v193, v5
v_dot2c_f32_bf16 v22, v182, v6
v_dot2c_f32_bf16 v23, v186, v6
v_dot2c_f32_bf16 v24, v190, v6
v_dot2c_f32_bf16 v25, v194, v6
v_dot2c_f32_bf16 v22, v183, v7
v_dot2c_f32_bf16 v23, v187, v7
v_dot2c_f32_bf16 v24, v191, v7
v_dot2c_f32_bf16 v25, v195, v7
s_mov_b32 s58, 262144
buffer_load_dwordx4 v[180:183], v2, s[24:27], s58 offen offset:0 nt
buffer_load_dwordx4 v[184:187], v2, s[24:27], s58 offen offset:1024 nt
buffer_load_dwordx4 v[188:191], v2, s[24:27], s58 offen offset:2048 nt
buffer_load_dwordx4 v[192:195], v2, s[24:27], s58 offen offset:3072 nt
v_add_f32_dpp v26, v22, v22 row_ror:8 row_mask:0xf bank_mask:0x3
v_add_f32_dpp v27, v23, v23 row_ror:8 row_mask:0xf bank_mask:0x3
s_nop 0
v_add_f32_dpp v26, v24, v24 row_ror:8 row_mask:0xf bank_mask:0xc
v_add_f32_dpp v27, v25, v25 row_ror:8 row_mask:0xf bank_mask:0xc
s_nop 0
v_add_f32_dpp v28, v26, v26 row_half_mirror row_mask:0xf bank_mask:0x5
s_nop 1
v_add_f32_dpp v28, v27, v27 row_half_mirror row_mask:0xf bank_mask:0xa
s_nop 1
v_add_f32_dpp v28, v28, v28 quad_perm:[1,0,3,2] row_mask:0xf bank_mask:0xf
s_nop 1
v_add_f32_dpp v28, v28, v28 quad_perm:[2,3,0,1] row_mask:0xf bank_mask:0xf
v_cvt_pk_bf16_f32 v28, v28, v28
v_and_b32 v28, s62, v28
v_mul_f32 v28, s60, v28
v_cvt_pk_bf16_f32 v28, v28, v28
v_and_b32 v28, s62, v28
s_nop 1
v_max_f32_dpp v29, v28, v28 row_ror:8 row_mask:0xf bank_mask:0xf
s_nop 1
v_max_f32_dpp v29, v29, v29 row_ror:4 row_mask:0xf bank_mask:0xf
v_max_f32 v29, v29, v16
v_sub_f32 v30, v16, v29
v_sub_f32 v31, v28, v29
v_mov_b32 v16, v29
v_mul_f32 v30, s61, v30
v_mul_f32 v31, s61, v31
v_exp_f32 v30, v30
v_exp_f32 v31, v31
s_nop 0
v_fma_f32 v17, v17, v30, v31
v_cvt_pk_bf16_f32 v32, v31, 0
v_cvt_pk_bf16_f32 v33, 0, v31
v_mul_f32 v8, v8, v30
v_mul_f32 v9, v9, v30
v_mul_f32 v10, v10, v30
v_mul_f32 v11, v11, v30
v_mul_f32 v12, v12, v30
v_mul_f32 v13, v13, v30
v_mul_f32 v14, v14, v30
v_mul_f32 v15, v15, v30
s_waitcnt vmcnt(28)
v_dot2c_f32_bf16_dpp v8, v32, v196 row_newbcast:0 row_mask:0xf bank_mask:0xf
v_dot2c_f32_bf16_dpp v9, v33, v196 row_newbcast:0 row_mask:0xf bank_mask:0xf
v_dot2c_f32_bf16_dpp v10, v32, v197 row_newbcast:0 row_mask:0xf bank_mask:0xf
v_dot2c_f32_bf16_dpp v11, v33, v197 row_newbcast:0 row_mask:0xf bank_mask:0xf
v_dot2c_f32_bf16_dpp v12, v32, v198 row_newbcast:0 row_mask:0xf bank_mask:0xf
v_dot2c_f32_bf16_dpp v13, v33, v198 row_newbcast:0 row_mask:0xf bank_mask:0xf
v_dot2c_f32_bf16_dpp v14, v32, v199 row_newbcast:0 row_mask:0xf bank_mask:0xf
v_dot2c_f32_bf16_dpp v15, v33, v199 row_newbcast:0 row_mask:0xf bank_mask:0xf
v_dot2c_f32_bf16_dpp v8, v32, v200 row_newbcast:4 row_mask:0xf bank_mask:0xf
v_dot2c_f32_bf16_dpp v9, v33, v200 row_newbcast:4 row_mask:0xf bank_mask:0xf
v_dot2c_f32_bf16_dpp v10, v32, v201 row_newbcast:4 row_mask:0xf bank_mask:0xf
v_dot2c_f32_bf16_dpp v11, v33, v201 row_newbcast:4 row_mask:0xf bank_mask:0xf
v_dot2c_f32_bf16_dpp v12, v32, v202 row_newbcast:4 row_mask:0xf bank_mask:0xf
v_dot2c_f32_bf16_dpp v13, v33, v202 row_newbcast:4 row_mask:0xf bank_mask:0xf
v_dot2c_f32_bf16_dpp v14, v32, v203 row_newbcast:4 row_mask:0xf bank_mask:0xf
v_dot2c_f32_bf16_dpp v15, v33, v203 row_newbcast:4 row_mask:0xf bank_mask:0xf
v_dot2c_f32_bf16_dpp v8, v32, v204 row_newbcast:8 row_mask:0xf bank_mask:0xf
v_dot2c_f32_bf16_dpp v9, v33, v204 row_newbcast:8 row_mask:0xf bank_mask:0xf
v_dot2c_f32_bf16_dpp v10, v32, v205 row_newbcast:8 row_mask:0xf bank_mask:0xf
v_dot2c_f32_bf16_dpp v11, v33, v205 row_newbcast:8 row_mask:0xf bank_mask:0xf
v_dot2c_f32_bf16_dpp v12, v32, v206 row_newbcast:8 row_mask:0xf bank_mask:0xf
v_dot2c_f32_bf16_dpp v13, v33, v206 row_newbcast:8 row_mask:0xf bank_mask:0xf
v_dot2c_f32_bf16_dpp v14, v32, v207 row_newbcast:8 row_mask:0xf bank_mask:0xf
v_dot2c_f32_bf16_dpp v15, v33, v207 row_newbcast:8 row_mask:0xf bank_mask:0xf
v_dot2c_f32_bf16_dpp v8, v32, v208 row_newbcast:12 row_mask:0xf bank_mask:0xf
v_dot2c_f32_bf16_dpp v9, v33, v208 row_newbcast:12 row_mask:0xf bank_mask:0xf
v_dot2c_f32_bf16_dpp v10, v32, v209 row_newbcast:12 row_mask:0xf bank_mask:0xf
v_dot2c_f32_bf16_dpp v11, v33, v209 row_newbcast:12 row_mask:0xf bank_mask:0xf
v_dot2c_f32_bf16_dpp v12, v32, v210 row_newbcast:12 row_mask:0xf bank_mask:0xf
v_dot2c_f32_bf16_dpp v13, v33, v210 row_newbcast:12 row_mask:0xf bank_mask:0xf
v_dot2c_f32_bf16_dpp v14, v32, v211 row_newbcast:12 row_mask:0xf bank_mask:0xf
v_dot2c_f32_bf16_dpp v15, v33, v211 row_newbcast:12 row_mask:0xf bank_mask:0xf
s_mov_b32 s58, 262144
buffer_load_dwordx4 v[196:199], v2, s[28:31], s58 offen offset:0 nt
buffer_load_dwordx4 v[200:203], v2, s[28:31], s58 offen offset:1024 nt
buffer_load_dwordx4 v[204:207], v2, s[28:31], s58 offen offset:2048 nt
buffer_load_dwordx4 v[208:211], v2, s[28:31], s58 offen offset:3072 nt
s_waitcnt vmcnt(28)
v_dot2_f32_bf16 v22, v212, v4, 0
v_dot2_f32_bf16 v23, v216, v4, 0
v_dot2_f32_bf16 v24, v220, v4, 0
v_dot2_f32_bf16 v25, v224, v4, 0
v_dot2c_f32_bf16 v22, v213, v5
v_dot2c_f32_bf16 v23, v217, v5
v_dot2c_f32_bf16 v24, v221, v5
v_dot2c_f32_bf16 v25, v225, v5
v_dot2c_f32_bf16 v22, v214, v6
v_dot2c_f32_bf16 v23, v218, v6
v_dot2c_f32_bf16 v24, v222, v6
v_dot2c_f32_bf16 v25, v226, v6
v_dot2c_f32_bf16 v22, v215, v7
v_dot2c_f32_bf16 v23, v219, v7
v_dot2c_f32_bf16 v24, v223, v7
v_dot2c_f32_bf16 v25, v227, v7
s_mov_b32 s58, 327680
buffer_load_dwordx4 v[212:215], v2, s[24:27], s58 offen offset:0 nt
buffer_load_dwordx4 v[216:219], v2, s[24:27], s58 offen offset:1024 nt
buffer_load_dwordx4 v[220:223], v2, s[24:27], s58 offen offset:2048 nt
buffer_load_dwordx4 v[224:227], v2, s[24:27], s58 offen offset:3072 nt
v_add_f32_dpp v26, v22, v22 row_ror:8 row_mask:0xf bank_mask:0x3
v_add_f32_dpp v27, v23, v23 row_ror:8 row_mask:0xf bank_mask:0x3
s_nop 0
v_add_f32_dpp v26, v24, v24 row_ror:8 row_mask:0xf bank_mask:0xc
v_add_f32_dpp v27, v25, v25 row_ror:8 row_mask:0xf bank_mask:0xc
s_nop 0
v_add_f32_dpp v28, v26, v26 row_half_mirror row_mask:0xf bank_mask:0x5
s_nop 1
v_add_f32_dpp v28, v27, v27 row_half_mirror row_mask:0xf bank_mask:0xa
s_nop 1
v_add_f32_dpp v28, v28, v28 quad_perm:[1,0,3,2] row_mask:0xf bank_mask:0xf
s_nop 1
v_add_f32_dpp v28, v28, v28 quad_perm:[2,3,0,1] row_mask:0xf bank_mask:0xf
v_cvt_pk_bf16_f32 v28, v28, v28
v_and_b32 v28, s62, v28
v_mul_f32 v28, s60, v28
v_cvt_pk_bf16_f32 v28, v28, v28
v_and_b32 v28, s62, v28
s_nop 1
v_max_f32_dpp v29, v28, v28 row_ror:8 row_mask:0xf bank_mask:0xf
s_nop 1
v_max_f32_dpp v29, v29, v29 row_ror:4 row_mask:0xf bank_mask:0xf
v_max_f32 v29, v29, v16
v_sub_f32 v30, v16, v29
v_sub_f32 v31, v28, v29
v_mov_b32 v16, v29
v_mul_f32 v30, s61, v30
v_mul_f32 v31, s61, v31
v_exp_f32 v30, v30
v_exp_f32 v31, v31
s_nop 0
v_fma_f32 v17, v17, v30, v31
v_cvt_pk_bf16_f32 v32, v31, 0
v_cvt_pk_bf16_f32 v33, 0, v31
v_mul_f32 v8, v8, v30
v_mul_f32 v9, v9, v30
v_mul_f32 v10, v10, v30
v_mul_f32 v11, v11, v30
v_mul_f32 v12, v12, v30
v_mul_f32 v13, v13, v30
v_mul_f32 v14, v14, v30
v_mul_f32 v15, v15, v30
s_waitcnt vmcnt(28)
v_dot2c_f32_bf16_dpp v8, v32, v228 row_newbcast:0 row_mask:0xf bank_mask:0xf
v_dot2c_f32_bf16_dpp v9, v33, v228 row_newbcast:0 row_mask:0xf bank_mask:0xf
v_dot2c_f32_bf16_dpp v10, v32, v229 row_newbcast:0 row_mask:0xf bank_mask:0xf
v_dot2c_f32_bf16_dpp v11, v33, v229 row_newbcast:0 row_mask:0xf bank_mask:0xf
v_dot2c_f32_bf16_dpp v12, v32, v230 row_newbcast:0 row_mask:0xf bank_mask:0xf
v_dot2c_f32_bf16_dpp v13, v33, v230 row_newbcast:0 row_mask:0xf bank_mask:0xf
v_dot2c_f32_bf16_dpp v14, v32, v231 row_newbcast:0 row_mask:0xf bank_mask:0xf
v_dot2c_f32_bf16_dpp v15, v33, v231 row_newbcast:0 row_mask:0xf bank_mask:0xf
v_dot2c_f32_bf16_dpp v8, v32, v232 row_newbcast:4 row_mask:0xf bank_mask:0xf
v_dot2c_f32_bf16_dpp v9, v33, v232 row_newbcast:4 row_mask:0xf bank_mask:0xf
v_dot2c_f32_bf16_dpp v10, v32, v233 row_newbcast:4 row_mask:0xf bank_mask:0xf
v_dot2c_f32_bf16_dpp v11, v33, v233 row_newbcast:4 row_mask:0xf bank_mask:0xf
v_dot2c_f32_bf16_dpp v12, v32, v234 row_newbcast:4 row_mask:0xf bank_mask:0xf
v_dot2c_f32_bf16_dpp v13, v33, v234 row_newbcast:4 row_mask:0xf bank_mask:0xf
v_dot2c_f32_bf16_dpp v14, v32, v235 row_newbcast:4 row_mask:0xf bank_mask:0xf
v_dot2c_f32_bf16_dpp v15, v33, v235 row_newbcast:4 row_mask:0xf bank_mask:0xf
v_dot2c_f32_bf16_dpp v8, v32, v236 row_newbcast:8 row_mask:0xf bank_mask:0xf
v_dot2c_f32_bf16_dpp v9, v33, v236 row_newbcast:8 row_mask:0xf bank_mask:0xf
v_dot2c_f32_bf16_dpp v10, v32, v237 row_newbcast:8 row_mask:0xf bank_mask:0xf
v_dot2c_f32_bf16_dpp v11, v33, v237 row_newbcast:8 row_mask:0xf bank_mask:0xf
v_dot2c_f32_bf16_dpp v12, v32, v238 row_newbcast:8 row_mask:0xf bank_mask:0xf
v_dot2c_f32_bf16_dpp v13, v33, v238 row_newbcast:8 row_mask:0xf bank_mask:0xf
v_dot2c_f32_bf16_dpp v14, v32, v239 row_newbcast:8 row_mask:0xf bank_mask:0xf
v_dot2c_f32_bf16_dpp v15, v33, v239 row_newbcast:8 row_mask:0xf bank_mask:0xf
v_dot2c_f32_bf16_dpp v8, v32, v240 row_newbcast:12 row_mask:0xf bank_mask:0xf
v_dot2c_f32_bf16_dpp v9, v33, v240 row_newbcast:12 row_mask:0xf bank_mask:0xf
v_dot2c_f32_bf16_dpp v10, v32, v241 row_newbcast:12 row_mask:0xf bank_mask:0xf
v_dot2c_f32_bf16_dpp v11, v33, v241 row_newbcast:12 row_mask:0xf bank_mask:0xf
v_dot2c_f32_bf16_dpp v12, v32, v242 row_newbcast:12 row_mask:0xf bank_mask:0xf
v_dot2c_f32_bf16_dpp v13, v33, v242 row_newbcast:12 row_mask:0xf bank_mask:0xf
v_dot2c_f32_bf16_dpp v14, v32, v243 row_newbcast:12 row_mask:0xf bank_mask:0xf
v_dot2c_f32_bf16_dpp v15, v33, v243 row_newbcast:12 row_mask:0xf bank_mask:0xf
s_mov_b32 s58, 327680
buffer_load_dwordx4 v[228:231], v2, s[28:31], s58 offen offset:0 nt
buffer_load_dwordx4 v[232:235], v2, s[28:31], s58 offen offset:1024 nt
buffer_load_dwordx4 v[236:239], v2, s[28:31], s58 offen offset:2048 nt
buffer_load_dwordx4 v[240:243], v2, s[28:31], s58 offen offset:3072 nt
s_waitcnt vmcnt(28)
v_dot2_f32_bf16 v22, v148, v4, 0
v_dot2_f32_bf16 v23, v152, v4, 0
v_dot2_f32_bf16 v24, v156, v4, 0
v_dot2_f32_bf16 v25, v160, v4, 0
v_dot2c_f32_bf16 v22, v149, v5
v_dot2c_f32_bf16 v23, v153, v5
v_dot2c_f32_bf16 v24, v157, v5
v_dot2c_f32_bf16 v25, v161, v5
v_dot2c_f32_bf16 v22, v150, v6
v_dot2c_f32_bf16 v23, v154, v6
v_dot2c_f32_bf16 v24, v158, v6
v_dot2c_f32_bf16 v25, v162, v6
v_dot2c_f32_bf16 v22, v151, v7
v_dot2c_f32_bf16 v23, v155, v7
v_dot2c_f32_bf16 v24, v159, v7
v_dot2c_f32_bf16 v25, v163, v7
s_mov_b32 s58, 393216
buffer_load_dwordx4 v[148:151], v2, s[24:27], s58 offen offset:0 nt
buffer_load_dwordx4 v[152:155], v2, s[24:27], s58 offen offset:1024 nt
buffer_load_dwordx4 v[156:159], v2, s[24:27], s58 offen offset:2048 nt
buffer_load_dwordx4 v[160:163], v2, s[24:27], s58 offen offset:3072 nt
v_add_f32_dpp v26, v22, v22 row_ror:8 row_mask:0xf bank_mask:0x3
v_add_f32_dpp v27, v23, v23 row_ror:8 row_mask:0xf bank_mask:0x3
s_nop 0
v_add_f32_dpp v26, v24, v24 row_ror:8 row_mask:0xf bank_mask:0xc
v_add_f32_dpp v27, v25, v25 row_ror:8 row_mask:0xf bank_mask:0xc
s_nop 0
v_add_f32_dpp v28, v26, v26 row_half_mirror row_mask:0xf bank_mask:0x5
s_nop 1
v_add_f32_dpp v28, v27, v27 row_half_mirror row_mask:0xf bank_mask:0xa
s_nop 1
v_add_f32_dpp v28, v28, v28 quad_perm:[1,0,3,2] row_mask:0xf bank_mask:0xf
s_nop 1
v_add_f32_dpp v28, v28, v28 quad_perm:[2,3,0,1] row_mask:0xf bank_mask:0xf
v_cvt_pk_bf16_f32 v28, v28, v28
v_and_b32 v28, s62, v28
v_mul_f32 v28, s60, v28
v_cvt_pk_bf16_f32 v28, v28, v28
v_and_b32 v28, s62, v28
s_nop 1
v_max_f32_dpp v29, v28, v28 row_ror:8 row_mask:0xf bank_mask:0xf
s_nop 1
v_max_f32_dpp v29, v29, v29 row_ror:4 row_mask:0xf bank_mask:0xf
v_max_f32 v29, v29, v16
v_sub_f32 v30, v16, v29
v_sub_f32 v31, v28, v29
v_mov_b32 v16, v29
v_mul_f32 v30, s61, v30
v_mul_f32 v31, s61, v31
v_exp_f32 v30, v30
v_exp_f32 v31, v31
s_nop 0
v_fma_f32 v17, v17, v30, v31
v_cvt_pk_bf16_f32 v32, v31, 0
v_cvt_pk_bf16_f32 v33, 0, v31
v_mul_f32 v8, v8, v30
v_mul_f32 v9, v9, v30
v_mul_f32 v10, v10, v30
v_mul_f32 v11, v11, v30
v_mul_f32 v12, v12, v30
v_mul_f32 v13, v13, v30
v_mul_f32 v14, v14, v30
v_mul_f32 v15, v15, v30
s_waitcnt vmcnt(28)
v_dot2c_f32_bf16_dpp v8, v32, v164 row_newbcast:0 row_mask:0xf bank_mask:0xf
v_dot2c_f32_bf16_dpp v9, v33, v164 row_newbcast:0 row_mask:0xf bank_mask:0xf
v_dot2c_f32_bf16_dpp v10, v32, v165 row_newbcast:0 row_mask:0xf bank_mask:0xf
v_dot2c_f32_bf16_dpp v11, v33, v165 row_newbcast:0 row_mask:0xf bank_mask:0xf
v_dot2c_f32_bf16_dpp v12, v32, v166 row_newbcast:0 row_mask:0xf bank_mask:0xf
v_dot2c_f32_bf16_dpp v13, v33, v166 row_newbcast:0 row_mask:0xf bank_mask:0xf
v_dot2c_f32_bf16_dpp v14, v32, v167 row_newbcast:0 row_mask:0xf bank_mask:0xf
v_dot2c_f32_bf16_dpp v15, v33, v167 row_newbcast:0 row_mask:0xf bank_mask:0xf
v_dot2c_f32_bf16_dpp v8, v32, v168 row_newbcast:4 row_mask:0xf bank_mask:0xf
v_dot2c_f32_bf16_dpp v9, v33, v168 row_newbcast:4 row_mask:0xf bank_mask:0xf
v_dot2c_f32_bf16_dpp v10, v32, v169 row_newbcast:4 row_mask:0xf bank_mask:0xf
v_dot2c_f32_bf16_dpp v11, v33, v169 row_newbcast:4 row_mask:0xf bank_mask:0xf
v_dot2c_f32_bf16_dpp v12, v32, v170 row_newbcast:4 row_mask:0xf bank_mask:0xf
v_dot2c_f32_bf16_dpp v13, v33, v170 row_newbcast:4 row_mask:0xf bank_mask:0xf
v_dot2c_f32_bf16_dpp v14, v32, v171 row_newbcast:4 row_mask:0xf bank_mask:0xf
v_dot2c_f32_bf16_dpp v15, v33, v171 row_newbcast:4 row_mask:0xf bank_mask:0xf
v_dot2c_f32_bf16_dpp v8, v32, v172 row_newbcast:8 row_mask:0xf bank_mask:0xf
v_dot2c_f32_bf16_dpp v9, v33, v172 row_newbcast:8 row_mask:0xf bank_mask:0xf
v_dot2c_f32_bf16_dpp v10, v32, v173 row_newbcast:8 row_mask:0xf bank_mask:0xf
v_dot2c_f32_bf16_dpp v11, v33, v173 row_newbcast:8 row_mask:0xf bank_mask:0xf
v_dot2c_f32_bf16_dpp v12, v32, v174 row_newbcast:8 row_mask:0xf bank_mask:0xf
v_dot2c_f32_bf16_dpp v13, v33, v174 row_newbcast:8 row_mask:0xf bank_mask:0xf
v_dot2c_f32_bf16_dpp v14, v32, v175 row_newbcast:8 row_mask:0xf bank_mask:0xf
v_dot2c_f32_bf16_dpp v15, v33, v175 row_newbcast:8 row_mask:0xf bank_mask:0xf
v_dot2c_f32_bf16_dpp v8, v32, v176 row_newbcast:12 row_mask:0xf bank_mask:0xf
v_dot2c_f32_bf16_dpp v9, v33, v176 row_newbcast:12 row_mask:0xf bank_mask:0xf
v_dot2c_f32_bf16_dpp v10, v32, v177 row_newbcast:12 row_mask:0xf bank_mask:0xf
v_dot2c_f32_bf16_dpp v11, v33, v177 row_newbcast:12 row_mask:0xf bank_mask:0xf
v_dot2c_f32_bf16_dpp v12, v32, v178 row_newbcast:12 row_mask:0xf bank_mask:0xf
v_dot2c_f32_bf16_dpp v13, v33, v178 row_newbcast:12 row_mask:0xf bank_mask:0xf
v_dot2c_f32_bf16_dpp v14, v32, v179 row_newbcast:12 row_mask:0xf bank_mask:0xf
v_dot2c_f32_bf16_dpp v15, v33, v179 row_newbcast:12 row_mask:0xf bank_mask:0xf
s_mov_b32 s58, 393216
buffer_load_dwordx4 v[164:167], v2, s[28:31], s58 offen offset:0 nt
buffer_load_dwordx4 v[168:171], v2, s[28:31], s58 offen offset:1024 nt
buffer_load_dwordx4 v[172:175], v2, s[28:31], s58 offen offset:2048 nt
buffer_load_dwordx4 v[176:179], v2, s[28:31], s58 offen offset:3072 nt
s_waitcnt vmcnt(28)
v_dot2_f32_bf16 v22, v48, v4, 0
v_dot2_f32_bf16 v23, v52, v4, 0
v_dot2_f32_bf16 v24, v56, v4, 0
v_dot2_f32_bf16 v25, v60, v4, 0
v_dot2c_f32_bf16 v22, v49, v5
v_dot2c_f32_bf16 v23, v53, v5
v_dot2c_f32_bf16 v24, v57, v5
v_dot2c_f32_bf16 v25, v61, v5
v_dot2c_f32_bf16 v22, v50, v6
v_dot2c_f32_bf16 v23, v54, v6
v_dot2c_f32_bf16 v24, v58, v6
v_dot2c_f32_bf16 v25, v62, v6
v_dot2c_f32_bf16 v22, v51, v7
v_dot2c_f32_bf16 v23, v55, v7
v_dot2c_f32_bf16 v24, v59, v7
v_dot2c_f32_bf16 v25, v63, v7
v_add_f32_dpp v26, v22, v22 row_ror:8 row_mask:0xf bank_mask:0x3
v_add_f32_dpp v27, v23, v23 row_ror:8 row_mask:0xf bank_mask:0x3
s_nop 0
v_add_f32_dpp v26, v24, v24 row_ror:8 row_mask:0xf bank_mask:0xc
v_add_f32_dpp v27, v25, v25 row_ror:8 row_mask:0xf bank_mask:0xc
s_nop 0
v_add_f32_dpp v28, v26, v26 row_half_mirror row_mask:0xf bank_mask:0x5
s_nop 1
v_add_f32_dpp v28, v27, v27 row_half_mirror row_mask:0xf bank_mask:0xa
s_nop 1
v_add_f32_dpp v28, v28, v28 quad_perm:[1,0,3,2] row_mask:0xf bank_mask:0xf
s_nop 1
v_add_f32_dpp v28, v28, v28 quad_perm:[2,3,0,1] row_mask:0xf bank_mask:0xf
v_cvt_pk_bf16_f32 v28, v28, v28
v_and_b32 v28, s62, v28
v_mul_f32 v28, s60, v28
v_cvt_pk_bf16_f32 v28, v28, v28
v_and_b32 v28, s62, v28
s_nop 1
v_max_f32_dpp v29, v28, v28 row_ror:8 row_mask:0xf bank_mask:0xf
s_nop 1
v_max_f32_dpp v29, v29, v29 row_ror:4 row_mask:0xf bank_mask:0xf
v_max_f32 v29, v29, v16
v_sub_f32 v30, v16, v29
v_sub_f32 v31, v28, v29
v_mov_b32 v16, v29
v_mul_f32 v30, s61, v30
v_mul_f32 v31, s61, v31
v_exp_f32 v30, v30
v_exp_f32 v31, v31
s_nop 0
v_fma_f32 v17, v17, v30, v31
v_cvt_pk_bf16_f32 v32, v31, 0
v_cvt_pk_bf16_f32 v33, 0, v31
v_mul_f32 v8, v8, v30
v_mul_f32 v9, v9, v30
v_mul_f32 v10, v10, v30
v_mul_f32 v11, v11, v30
v_mul_f32 v12, v12, v30
v_mul_f32 v13, v13, v30
v_mul_f32 v14, v14, v30
v_mul_f32 v15, v15, v30
s_waitcnt vmcnt(24)
v_dot2c_f32_bf16_dpp v8, v32, v64 row_newbcast:0 row_mask:0xf bank_mask:0xf
v_dot2c_f32_bf16_dpp v9, v33, v64 row_newbcast:0 row_mask:0xf bank_mask:0xf
v_dot2c_f32_bf16_dpp v10, v32, v65 row_newbcast:0 row_mask:0xf bank_mask:0xf
v_dot2c_f32_bf16_dpp v11, v33, v65 row_newbcast:0 row_mask:0xf bank_mask:0xf
v_dot2c_f32_bf16_dpp v12, v32, v66 row_newbcast:0 row_mask:0xf bank_mask:0xf
v_dot2c_f32_bf16_dpp v13, v33, v66 row_newbcast:0 row_mask:0xf bank_mask:0xf
v_dot2c_f32_bf16_dpp v14, v32, v67 row_newbcast:0 row_mask:0xf bank_mask:0xf
v_dot2c_f32_bf16_dpp v15, v33, v67 row_newbcast:0 row_mask:0xf bank_mask:0xf
v_dot2c_f32_bf16_dpp v8, v32, v68 row_newbcast:4 row_mask:0xf bank_mask:0xf
v_dot2c_f32_bf16_dpp v9, v33, v68 row_newbcast:4 row_mask:0xf bank_mask:0xf
v_dot2c_f32_bf16_dpp v10, v32, v69 row_newbcast:4 row_mask:0xf bank_mask:0xf
v_dot2c_f32_bf16_dpp v11, v33, v69 row_newbcast:4 row_mask:0xf bank_mask:0xf
v_dot2c_f32_bf16_dpp v12, v32, v70 row_newbcast:4 row_mask:0xf bank_mask:0xf
v_dot2c_f32_bf16_dpp v13, v33, v70 row_newbcast:4 row_mask:0xf bank_mask:0xf
v_dot2c_f32_bf16_dpp v14, v32, v71 row_newbcast:4 row_mask:0xf bank_mask:0xf
v_dot2c_f32_bf16_dpp v15, v33, v71 row_newbcast:4 row_mask:0xf bank_mask:0xf
v_dot2c_f32_bf16_dpp v8, v32, v72 row_newbcast:8 row_mask:0xf bank_mask:0xf
v_dot2c_f32_bf16_dpp v9, v33, v72 row_newbcast:8 row_mask:0xf bank_mask:0xf
v_dot2c_f32_bf16_dpp v10, v32, v73 row_newbcast:8 row_mask:0xf bank_mask:0xf
v_dot2c_f32_bf16_dpp v11, v33, v73 row_newbcast:8 row_mask:0xf bank_mask:0xf
v_dot2c_f32_bf16_dpp v12, v32, v74 row_newbcast:8 row_mask:0xf bank_mask:0xf
v_dot2c_f32_bf16_dpp v13, v33, v74 row_newbcast:8 row_mask:0xf bank_mask:0xf
v_dot2c_f32_bf16_dpp v14, v32, v75 row_newbcast:8 row_mask:0xf bank_mask:0xf
v_dot2c_f32_bf16_dpp v15, v33, v75 row_newbcast:8 row_mask:0xf bank_mask:0xf
v_dot2c_f32_bf16_dpp v8, v32, v76 row_newbcast:12 row_mask:0xf bank_mask:0xf
v_dot2c_f32_bf16_dpp v9, v33, v76 row_newbcast:12 row_mask:0xf bank_mask:0xf
v_dot2c_f32_bf16_dpp v10, v32, v77 row_newbcast:12 row_mask:0xf bank_mask:0xf
v_dot2c_f32_bf16_dpp v11, v33, v77 row_newbcast:12 row_mask:0xf bank_mask:0xf
v_dot2c_f32_bf16_dpp v12, v32, v78 row_newbcast:12 row_mask:0xf bank_mask:0xf
v_dot2c_f32_bf16_dpp v13, v33, v78 row_newbcast:12 row_mask:0xf bank_mask:0xf
v_dot2c_f32_bf16_dpp v14, v32, v79 row_newbcast:12 row_mask:0xf bank_mask:0xf
v_dot2c_f32_bf16_dpp v15, v33, v79 row_newbcast:12 row_mask:0xf bank_mask:0xf
s_waitcnt vmcnt(20)
v_dot2_f32_bf16 v22, v180, v4, 0
v_dot2_f32_bf16 v23, v184, v4, 0
v_dot2_f32_bf16 v24, v188, v4, 0
v_dot2_f32_bf16 v25, v192, v4, 0
v_dot2c_f32_bf16 v22, v181, v5
v_dot2c_f32_bf16 v23, v185, v5
v_dot2c_f32_bf16 v24, v189, v5
v_dot2c_f32_bf16 v25, v193, v5
v_dot2c_f32_bf16 v22, v182, v6
v_dot2c_f32_bf16 v23, v186, v6
v_dot2c_f32_bf16 v24, v190, v6
v_dot2c_f32_bf16 v25, v194, v6
v_dot2c_f32_bf16 v22, v183, v7
v_dot2c_f32_bf16 v23, v187, v7
v_dot2c_f32_bf16 v24, v191, v7
v_dot2c_f32_bf16 v25, v195, v7
s_mov_b32 s58, 458752
buffer_load_dwordx4 v[180:183], v2, s[24:27], s58 offen offset:0 nt
buffer_load_dwordx4 v[184:187], v2, s[24:27], s58 offen offset:1024 nt
buffer_load_dwordx4 v[188:191], v2, s[24:27], s58 offen offset:2048 nt
buffer_load_dwordx4 v[192:195], v2, s[24:27], s58 offen offset:3072 nt
v_add_f32_dpp v26, v22, v22 row_ror:8 row_mask:0xf bank_mask:0x3
v_add_f32_dpp v27, v23, v23 row_ror:8 row_mask:0xf bank_mask:0x3
s_nop 0
v_add_f32_dpp v26, v24, v24 row_ror:8 row_mask:0xf bank_mask:0xc
v_add_f32_dpp v27, v25, v25 row_ror:8 row_mask:0xf bank_mask:0xc
s_nop 0
v_add_f32_dpp v28, v26, v26 row_half_mirror row_mask:0xf bank_mask:0x5
s_nop 1
v_add_f32_dpp v28, v27, v27 row_half_mirror row_mask:0xf bank_mask:0xa
s_nop 1
v_add_f32_dpp v28, v28, v28 quad_perm:[1,0,3,2] row_mask:0xf bank_mask:0xf
s_nop 1
v_add_f32_dpp v28, v28, v28 quad_perm:[2,3,0,1] row_mask:0xf bank_mask:0xf
v_cvt_pk_bf16_f32 v28, v28, v28
v_and_b32 v28, s62, v28
v_mul_f32 v28, s60, v28
v_cvt_pk_bf16_f32 v28, v28, v28
v_and_b32 v28, s62, v28
s_nop 1
v_max_f32_dpp v29, v28, v28 row_ror:8 row_mask:0xf bank_mask:0xf
s_nop 1
v_max_f32_dpp v29, v29, v29 row_ror:4 row_mask:0xf bank_mask:0xf
v_max_f32 v29, v29, v16
v_sub_f32 v30, v16, v29
v_sub_f32 v31, v28, v29
v_mov_b32 v16, v29
v_mul_f32 v30, s61, v30
v_mul_f32 v31, s61, v31
v_exp_f32 v30, v30
v_exp_f32 v31, v31
s_nop 0
v_fma_f32 v17, v17, v30, v31
v_cvt_pk_bf16_f32 v32, v31, 0
v_cvt_pk_bf16_f32 v33, 0, v31
v_mul_f32 v8, v8, v30
v_mul_f32 v9, v9, v30
v_mul_f32 v10, v10, v30
v_mul_f32 v11, v11, v30
v_mul_f32 v12, v12, v30
v_mul_f32 v13, v13, v30
v_mul_f32 v14, v14, v30
v_mul_f32 v15, v15, v30
s_waitcnt vmcnt(20)
v_dot2c_f32_bf16_dpp v8, v32, v196 row_newbcast:0 row_mask:0xf bank_mask:0xf
v_dot2c_f32_bf16_dpp v9, v33, v196 row_newbcast:0 row_mask:0xf bank_mask:0xf
v_dot2c_f32_bf16_dpp v10, v32, v197 row_newbcast:0 row_mask:0xf bank_mask:0xf
v_dot2c_f32_bf16_dpp v11, v33, v197 row_newbcast:0 row_mask:0xf bank_mask:0xf
v_dot2c_f32_bf16_dpp v12, v32, v198 row_newbcast:0 row_mask:0xf bank_mask:0xf
v_dot2c_f32_bf16_dpp v13, v33, v198 row_newbcast:0 row_mask:0xf bank_mask:0xf
v_dot2c_f32_bf16_dpp v14, v32, v199 row_newbcast:0 row_mask:0xf bank_mask:0xf
v_dot2c_f32_bf16_dpp v15, v33, v199 row_newbcast:0 row_mask:0xf bank_mask:0xf
v_dot2c_f32_bf16_dpp v8, v32, v200 row_newbcast:4 row_mask:0xf bank_mask:0xf
v_dot2c_f32_bf16_dpp v9, v33, v200 row_newbcast:4 row_mask:0xf bank_mask:0xf
v_dot2c_f32_bf16_dpp v10, v32, v201 row_newbcast:4 row_mask:0xf bank_mask:0xf
v_dot2c_f32_bf16_dpp v11, v33, v201 row_newbcast:4 row_mask:0xf bank_mask:0xf
v_dot2c_f32_bf16_dpp v12, v32, v202 row_newbcast:4 row_mask:0xf bank_mask:0xf
v_dot2c_f32_bf16_dpp v13, v33, v202 row_newbcast:4 row_mask:0xf bank_mask:0xf
v_dot2c_f32_bf16_dpp v14, v32, v203 row_newbcast:4 row_mask:0xf bank_mask:0xf
v_dot2c_f32_bf16_dpp v15, v33, v203 row_newbcast:4 row_mask:0xf bank_mask:0xf
v_dot2c_f32_bf16_dpp v8, v32, v204 row_newbcast:8 row_mask:0xf bank_mask:0xf
v_dot2c_f32_bf16_dpp v9, v33, v204 row_newbcast:8 row_mask:0xf bank_mask:0xf
v_dot2c_f32_bf16_dpp v10, v32, v205 row_newbcast:8 row_mask:0xf bank_mask:0xf
v_dot2c_f32_bf16_dpp v11, v33, v205 row_newbcast:8 row_mask:0xf bank_mask:0xf
v_dot2c_f32_bf16_dpp v12, v32, v206 row_newbcast:8 row_mask:0xf bank_mask:0xf
v_dot2c_f32_bf16_dpp v13, v33, v206 row_newbcast:8 row_mask:0xf bank_mask:0xf
v_dot2c_f32_bf16_dpp v14, v32, v207 row_newbcast:8 row_mask:0xf bank_mask:0xf
v_dot2c_f32_bf16_dpp v15, v33, v207 row_newbcast:8 row_mask:0xf bank_mask:0xf
v_dot2c_f32_bf16_dpp v8, v32, v208 row_newbcast:12 row_mask:0xf bank_mask:0xf
v_dot2c_f32_bf16_dpp v9, v33, v208 row_newbcast:12 row_mask:0xf bank_mask:0xf
v_dot2c_f32_bf16_dpp v10, v32, v209 row_newbcast:12 row_mask:0xf bank_mask:0xf
v_dot2c_f32_bf16_dpp v11, v33, v209 row_newbcast:12 row_mask:0xf bank_mask:0xf
v_dot2c_f32_bf16_dpp v12, v32, v210 row_newbcast:12 row_mask:0xf bank_mask:0xf
v_dot2c_f32_bf16_dpp v13, v33, v210 row_newbcast:12 row_mask:0xf bank_mask:0xf
v_dot2c_f32_bf16_dpp v14, v32, v211 row_newbcast:12 row_mask:0xf bank_mask:0xf
v_dot2c_f32_bf16_dpp v15, v33, v211 row_newbcast:12 row_mask:0xf bank_mask:0xf
s_mov_b32 s58, 458752
buffer_load_dwordx4 v[196:199], v2, s[28:31], s58 offen offset:0 nt
buffer_load_dwordx4 v[200:203], v2, s[28:31], s58 offen offset:1024 nt
buffer_load_dwordx4 v[204:207], v2, s[28:31], s58 offen offset:2048 nt
buffer_load_dwordx4 v[208:211], v2, s[28:31], s58 offen offset:3072 nt
s_waitcnt vmcnt(20)
v_dot2_f32_bf16 v22, v212, v4, 0
v_dot2_f32_bf16 v23, v216, v4, 0
v_dot2_f32_bf16 v24, v220, v4, 0
v_dot2_f32_bf16 v25, v224, v4, 0
v_dot2c_f32_bf16 v22, v213, v5
v_dot2c_f32_bf16 v23, v217, v5
v_dot2c_f32_bf16 v24, v221, v5
v_dot2c_f32_bf16 v25, v225, v5
v_dot2c_f32_bf16 v22, v214, v6
v_dot2c_f32_bf16 v23, v218, v6
v_dot2c_f32_bf16 v24, v222, v6
v_dot2c_f32_bf16 v25, v226, v6
v_dot2c_f32_bf16 v22, v215, v7
v_dot2c_f32_bf16 v23, v219, v7
v_dot2c_f32_bf16 v24, v223, v7
v_dot2c_f32_bf16 v25, v227, v7
s_mov_b32 s58, 524288
buffer_load_dwordx4 v[212:215], v2, s[24:27], s58 offen offset:0 nt
buffer_load_dwordx4 v[216:219], v2, s[24:27], s58 offen offset:1024 nt
buffer_load_dwordx4 v[220:223], v2, s[24:27], s58 offen offset:2048 nt
buffer_load_dwordx4 v[224:227], v2, s[24:27], s58 offen offset:3072 nt
v_add_f32_dpp v26, v22, v22 row_ror:8 row_mask:0xf bank_mask:0x3
v_add_f32_dpp v27, v23, v23 row_ror:8 row_mask:0xf bank_mask:0x3
s_nop 0
v_add_f32_dpp v26, v24, v24 row_ror:8 row_mask:0xf bank_mask:0xc
v_add_f32_dpp v27, v25, v25 row_ror:8 row_mask:0xf bank_mask:0xc
s_nop 0
v_add_f32_dpp v28, v26, v26 row_half_mirror row_mask:0xf bank_mask:0x5
s_nop 1
v_add_f32_dpp v28, v27, v27 row_half_mirror row_mask:0xf bank_mask:0xa
s_nop 1
v_add_f32_dpp v28, v28, v28 quad_perm:[1,0,3,2] row_mask:0xf bank_mask:0xf
s_nop 1
v_add_f32_dpp v28, v28, v28 quad_perm:[2,3,0,1] row_mask:0xf bank_mask:0xf
v_cvt_pk_bf16_f32 v28, v28, v28
v_and_b32 v28, s62, v28
v_mul_f32 v28, s60, v28
v_cvt_pk_bf16_f32 v28, v28, v28
v_and_b32 v28, s62, v28
s_nop 1
v_max_f32_dpp v29, v28, v28 row_ror:8 row_mask:0xf bank_mask:0xf
s_nop 1
v_max_f32_dpp v29, v29, v29 row_ror:4 row_mask:0xf bank_mask:0xf
v_max_f32 v29, v29, v16
v_sub_f32 v30, v16, v29
v_sub_f32 v31, v28, v29
v_mov_b32 v16, v29
v_mul_f32 v30, s61, v30
v_mul_f32 v31, s61, v31
v_exp_f32 v30, v30
v_exp_f32 v31, v31
s_nop 0
v_fma_f32 v17, v17, v30, v31
v_cvt_pk_bf16_f32 v32, v31, 0
v_cvt_pk_bf16_f32 v33, 0, v31
v_mul_f32 v8, v8, v30
v_mul_f32 v9, v9, v30
v_mul_f32 v10, v10, v30
v_mul_f32 v11, v11, v30
v_mul_f32 v12, v12, v30
v_mul_f32 v13, v13, v30
v_mul_f32 v14, v14, v30
v_mul_f32 v15, v15, v30
s_waitcnt vmcnt(20)
v_dot2c_f32_bf16_dpp v8, v32, v228 row_newbcast:0 row_mask:0xf bank_mask:0xf
v_dot2c_f32_bf16_dpp v9, v33, v228 row_newbcast:0 row_mask:0xf bank_mask:0xf
v_dot2c_f32_bf16_dpp v10, v32, v229 row_newbcast:0 row_mask:0xf bank_mask:0xf
v_dot2c_f32_bf16_dpp v11, v33, v229 row_newbcast:0 row_mask:0xf bank_mask:0xf
v_dot2c_f32_bf16_dpp v12, v32, v230 row_newbcast:0 row_mask:0xf bank_mask:0xf
v_dot2c_f32_bf16_dpp v13, v33, v230 row_newbcast:0 row_mask:0xf bank_mask:0xf
v_dot2c_f32_bf16_dpp v14, v32, v231 row_newbcast:0 row_mask:0xf bank_mask:0xf
v_dot2c_f32_bf16_dpp v15, v33, v231 row_newbcast:0 row_mask:0xf bank_mask:0xf
v_dot2c_f32_bf16_dpp v8, v32, v232 row_newbcast:4 row_mask:0xf bank_mask:0xf
v_dot2c_f32_bf16_dpp v9, v33, v232 row_newbcast:4 row_mask:0xf bank_mask:0xf
v_dot2c_f32_bf16_dpp v10, v32, v233 row_newbcast:4 row_mask:0xf bank_mask:0xf
v_dot2c_f32_bf16_dpp v11, v33, v233 row_newbcast:4 row_mask:0xf bank_mask:0xf
v_dot2c_f32_bf16_dpp v12, v32, v234 row_newbcast:4 row_mask:0xf bank_mask:0xf
v_dot2c_f32_bf16_dpp v13, v33, v234 row_newbcast:4 row_mask:0xf bank_mask:0xf
v_dot2c_f32_bf16_dpp v14, v32, v235 row_newbcast:4 row_mask:0xf bank_mask:0xf
v_dot2c_f32_bf16_dpp v15, v33, v235 row_newbcast:4 row_mask:0xf bank_mask:0xf
v_dot2c_f32_bf16_dpp v8, v32, v236 row_newbcast:8 row_mask:0xf bank_mask:0xf
v_dot2c_f32_bf16_dpp v9, v33, v236 row_newbcast:8 row_mask:0xf bank_mask:0xf
v_dot2c_f32_bf16_dpp v10, v32, v237 row_newbcast:8 row_mask:0xf bank_mask:0xf
v_dot2c_f32_bf16_dpp v11, v33, v237 row_newbcast:8 row_mask:0xf bank_mask:0xf
v_dot2c_f32_bf16_dpp v12, v32, v238 row_newbcast:8 row_mask:0xf bank_mask:0xf
v_dot2c_f32_bf16_dpp v13, v33, v238 row_newbcast:8 row_mask:0xf bank_mask:0xf
v_dot2c_f32_bf16_dpp v14, v32, v239 row_newbcast:8 row_mask:0xf bank_mask:0xf
v_dot2c_f32_bf16_dpp v15, v33, v239 row_newbcast:8 row_mask:0xf bank_mask:0xf
v_dot2c_f32_bf16_dpp v8, v32, v240 row_newbcast:12 row_mask:0xf bank_mask:0xf
v_dot2c_f32_bf16_dpp v9, v33, v240 row_newbcast:12 row_mask:0xf bank_mask:0xf
v_dot2c_f32_bf16_dpp v10, v32, v241 row_newbcast:12 row_mask:0xf bank_mask:0xf
v_dot2c_f32_bf16_dpp v11, v33, v241 row_newbcast:12 row_mask:0xf bank_mask:0xf
v_dot2c_f32_bf16_dpp v12, v32, v242 row_newbcast:12 row_mask:0xf bank_mask:0xf
v_dot2c_f32_bf16_dpp v13, v33, v242 row_newbcast:12 row_mask:0xf bank_mask:0xf
v_dot2c_f32_bf16_dpp v14, v32, v243 row_newbcast:12 row_mask:0xf bank_mask:0xf
v_dot2c_f32_bf16_dpp v15, v33, v243 row_newbcast:12 row_mask:0xf bank_mask:0xf
s_mov_b32 s58, 524288
buffer_load_dwordx4 v[228:231], v2, s[28:31], s58 offen offset:0 nt
buffer_load_dwordx4 v[232:235], v2, s[28:31], s58 offen offset:1024 nt
buffer_load_dwordx4 v[236:239], v2, s[28:31], s58 offen offset:2048 nt
buffer_load_dwordx4 v[240:243], v2, s[28:31], s58 offen offset:3072 nt
s_waitcnt vmcnt(20)
v_dot2_f32_bf16 v22, v148, v4, 0
v_dot2_f32_bf16 v23, v152, v4, 0
v_dot2_f32_bf16 v24, v156, v4, 0
v_dot2_f32_bf16 v25, v160, v4, 0
v_dot2c_f32_bf16 v22, v149, v5
v_dot2c_f32_bf16 v23, v153, v5
v_dot2c_f32_bf16 v24, v157, v5
v_dot2c_f32_bf16 v25, v161, v5
v_dot2c_f32_bf16 v22, v150, v6
v_dot2c_f32_bf16 v23, v154, v6
v_dot2c_f32_bf16 v24, v158, v6
v_dot2c_f32_bf16 v25, v162, v6
v_dot2c_f32_bf16 v22, v151, v7
v_dot2c_f32_bf16 v23, v155, v7
v_dot2c_f32_bf16 v24, v159, v7
v_dot2c_f32_bf16 v25, v163, v7
s_mov_b32 s58, 589824
buffer_load_dwordx4 v[148:151], v2, s[24:27], s58 offen offset:0 nt
buffer_load_dwordx4 v[152:155], v2, s[24:27], s58 offen offset:1024 nt
buffer_load_dwordx4 v[156:159], v2, s[24:27], s58 offen offset:2048 nt
buffer_load_dwordx4 v[160:163], v2, s[24:27], s58 offen offset:3072 nt
v_add_f32_dpp v26, v22, v22 row_ror:8 row_mask:0xf bank_mask:0x3
v_add_f32_dpp v27, v23, v23 row_ror:8 row_mask:0xf bank_mask:0x3
s_nop 0
v_add_f32_dpp v26, v24, v24 row_ror:8 row_mask:0xf bank_mask:0xc
v_add_f32_dpp v27, v25, v25 row_ror:8 row_mask:0xf bank_mask:0xc
s_nop 0
v_add_f32_dpp v28, v26, v26 row_half_mirror row_mask:0xf bank_mask:0x5
s_nop 1
v_add_f32_dpp v28, v27, v27 row_half_mirror row_mask:0xf bank_mask:0xa
s_nop 1
v_add_f32_dpp v28, v28, v28 quad_perm:[1,0,3,2] row_mask:0xf bank_mask:0xf
s_nop 1
v_add_f32_dpp v28, v28, v28 quad_perm:[2,3,0,1] row_mask:0xf bank_mask:0xf
v_cvt_pk_bf16_f32 v28, v28, v28
v_and_b32 v28, s62, v28
v_mul_f32 v28, s60, v28
v_cvt_pk_bf16_f32 v28, v28, v28
v_and_b32 v28, s62, v28
s_nop 1
v_max_f32_dpp v29, v28, v28 row_ror:8 row_mask:0xf bank_mask:0xf
s_nop 1
v_max_f32_dpp v29, v29, v29 row_ror:4 row_mask:0xf bank_mask:0xf
v_max_f32 v29, v29, v16
v_sub_f32 v30, v16, v29
v_sub_f32 v31, v28, v29
v_mov_b32 v16, v29
v_mul_f32 v30, s61, v30
v_mul_f32 v31, s61, v31
v_exp_f32 v30, v30
v_exp_f32 v31, v31
s_nop 0
v_fma_f32 v17, v17, v30, v31
v_cvt_pk_bf16_f32 v32, v31, 0
v_cvt_pk_bf16_f32 v33, 0, v31
v_mul_f32 v8, v8, v30
v_mul_f32 v9, v9, v30
v_mul_f32 v10, v10, v30
v_mul_f32 v11, v11, v30
v_mul_f32 v12, v12, v30
v_mul_f32 v13, v13, v30
v_mul_f32 v14, v14, v30
v_mul_f32 v15, v15, v30
s_waitcnt vmcnt(20)
v_dot2c_f32_bf16_dpp v8, v32, v164 row_newbcast:0 row_mask:0xf bank_mask:0xf
v_dot2c_f32_bf16_dpp v9, v33, v164 row_newbcast:0 row_mask:0xf bank_mask:0xf
v_dot2c_f32_bf16_dpp v10, v32, v165 row_newbcast:0 row_mask:0xf bank_mask:0xf
v_dot2c_f32_bf16_dpp v11, v33, v165 row_newbcast:0 row_mask:0xf bank_mask:0xf
v_dot2c_f32_bf16_dpp v12, v32, v166 row_newbcast:0 row_mask:0xf bank_mask:0xf
v_dot2c_f32_bf16_dpp v13, v33, v166 row_newbcast:0 row_mask:0xf bank_mask:0xf
v_dot2c_f32_bf16_dpp v14, v32, v167 row_newbcast:0 row_mask:0xf bank_mask:0xf
v_dot2c_f32_bf16_dpp v15, v33, v167 row_newbcast:0 row_mask:0xf bank_mask:0xf
v_dot2c_f32_bf16_dpp v8, v32, v168 row_newbcast:4 row_mask:0xf bank_mask:0xf
v_dot2c_f32_bf16_dpp v9, v33, v168 row_newbcast:4 row_mask:0xf bank_mask:0xf
v_dot2c_f32_bf16_dpp v10, v32, v169 row_newbcast:4 row_mask:0xf bank_mask:0xf
v_dot2c_f32_bf16_dpp v11, v33, v169 row_newbcast:4 row_mask:0xf bank_mask:0xf
v_dot2c_f32_bf16_dpp v12, v32, v170 row_newbcast:4 row_mask:0xf bank_mask:0xf
v_dot2c_f32_bf16_dpp v13, v33, v170 row_newbcast:4 row_mask:0xf bank_mask:0xf
v_dot2c_f32_bf16_dpp v14, v32, v171 row_newbcast:4 row_mask:0xf bank_mask:0xf
v_dot2c_f32_bf16_dpp v15, v33, v171 row_newbcast:4 row_mask:0xf bank_mask:0xf
v_dot2c_f32_bf16_dpp v8, v32, v172 row_newbcast:8 row_mask:0xf bank_mask:0xf
v_dot2c_f32_bf16_dpp v9, v33, v172 row_newbcast:8 row_mask:0xf bank_mask:0xf
v_dot2c_f32_bf16_dpp v10, v32, v173 row_newbcast:8 row_mask:0xf bank_mask:0xf
v_dot2c_f32_bf16_dpp v11, v33, v173 row_newbcast:8 row_mask:0xf bank_mask:0xf
v_dot2c_f32_bf16_dpp v12, v32, v174 row_newbcast:8 row_mask:0xf bank_mask:0xf
v_dot2c_f32_bf16_dpp v13, v33, v174 row_newbcast:8 row_mask:0xf bank_mask:0xf
v_dot2c_f32_bf16_dpp v14, v32, v175 row_newbcast:8 row_mask:0xf bank_mask:0xf
v_dot2c_f32_bf16_dpp v15, v33, v175 row_newbcast:8 row_mask:0xf bank_mask:0xf
v_dot2c_f32_bf16_dpp v8, v32, v176 row_newbcast:12 row_mask:0xf bank_mask:0xf
v_dot2c_f32_bf16_dpp v9, v33, v176 row_newbcast:12 row_mask:0xf bank_mask:0xf
v_dot2c_f32_bf16_dpp v10, v32, v177 row_newbcast:12 row_mask:0xf bank_mask:0xf
v_dot2c_f32_bf16_dpp v11, v33, v177 row_newbcast:12 row_mask:0xf bank_mask:0xf
v_dot2c_f32_bf16_dpp v12, v32, v178 row_newbcast:12 row_mask:0xf bank_mask:0xf
v_dot2c_f32_bf16_dpp v13, v33, v178 row_newbcast:12 row_mask:0xf bank_mask:0xf
v_dot2c_f32_bf16_dpp v14, v32, v179 row_newbcast:12 row_mask:0xf bank_mask:0xf
v_dot2c_f32_bf16_dpp v15, v33, v179 row_newbcast:12 row_mask:0xf bank_mask:0xf
s_mov_b32 s58, 589824
buffer_load_dwordx4 v[164:167], v2, s[28:31], s58 offen offset:0 nt
buffer_load_dwordx4 v[168:171], v2, s[28:31], s58 offen offset:1024 nt
buffer_load_dwordx4 v[172:175], v2, s[28:31], s58 offen offset:2048 nt
buffer_load_dwordx4 v[176:179], v2, s[28:31], s58 offen offset:3072 nt
s_nop 3
L_join:
s_waitcnt vmcnt(20)
v_dot2_f32_bf16 v22, v180, v4, 0
v_dot2_f32_bf16 v23, v184, v4, 0
v_dot2_f32_bf16 v24, v188, v4, 0
v_dot2_f32_bf16 v25, v192, v4, 0
v_dot2c_f32_bf16 v22, v181, v5
v_dot2c_f32_bf16 v23, v185, v5
v_dot2c_f32_bf16 v24, v189, v5
v_dot2c_f32_bf16 v25, v193, v5
v_dot2c_f32_bf16 v22, v182, v6
v_dot2c_f32_bf16 v23, v186, v6
v_dot2c_f32_bf16 v24, v190, v6
v_dot2c_f32_bf16 v25, v194, v6
v_dot2c_f32_bf16 v22, v183, v7
v_dot2c_f32_bf16 v23, v187, v7
v_dot2c_f32_bf16 v24, v191, v7
v_dot2c_f32_bf16 v25, v195, v7
s_mov_b32 s58, 655360
buffer_load_dwordx4 v[180:183], v2, s[24:27], s58 offen offset:0 nt
buffer_load_dwordx4 v[184:187], v2, s[24:27], s58 offen offset:1024 nt
buffer_load_dwordx4 v[188:191], v2, s[24:27], s58 offen offset:2048 nt
buffer_load_dwordx4 v[192:195], v2, s[24:27], s58 offen offset:3072 nt
v_add_f32_dpp v26, v22, v22 row_ror:8 row_mask:0xf bank_mask:0x3
v_add_f32_dpp v27, v23, v23 row_ror:8 row_mask:0xf bank_mask:0x3
s_nop 0
v_add_f32_dpp v26, v24, v24 row_ror:8 row_mask:0xf bank_mask:0xc
v_add_f32_dpp v27, v25, v25 row_ror:8 row_mask:0xf bank_mask:0xc
s_nop 0
v_add_f32_dpp v28, v26, v26 row_half_mirror row_mask:0xf bank_mask:0x5
s_nop 1
v_add_f32_dpp v28, v27, v27 row_half_mirror row_mask:0xf bank_mask:0xa
s_nop 1
v_add_f32_dpp v28, v28, v28 quad_perm:[1,0,3,2] row_mask:0xf bank_mask:0xf
s_nop 1
v_add_f32_dpp v28, v28, v28 quad_perm:[2,3,0,1] row_mask:0xf bank_mask:0xf
v_cvt_pk_bf16_f32 v28, v28, v28
v_and_b32 v28, s62, v28
v_mul_f32 v28, s60, v28
v_cvt_pk_bf16_f32 v28, v28, v28
v_and_b32 v28, s62, v28
s_nop 1
v_max_f32_dpp v29, v28, v28 row_ror:8 row_mask:0xf bank_mask:0xf
s_nop 1
v_max_f32_dpp v29, v29, v29 row_ror:4 row_mask:0xf bank_mask:0xf
v_max_f32 v29, v29, v16
v_sub_f32 v30, v16, v29
v_sub_f32 v31, v28, v29
v_mov_b32 v16, v29
v_mul_f32 v30, s61, v30
v_mul_f32 v31, s61, v31
v_exp_f32 v30, v30
v_exp_f32 v31, v31
s_nop 0
v_fma_f32 v17, v17, v30, v31
v_cvt_pk_bf16_f32 v32, v31, 0
v_cvt_pk_bf16_f32 v33, 0, v31
v_mul_f32 v8, v8, v30
v_mul_f32 v9, v9, v30
v_mul_f32 v10, v10, v30
v_mul_f32 v11, v11, v30
v_mul_f32 v12, v12, v30
v_mul_f32 v13, v13, v30
v_mul_f32 v14, v14, v30
v_mul_f32 v15, v15, v30
s_waitcnt vmcnt(20)
v_dot2c_f32_bf16_dpp v8, v32, v196 row_newbcast:0 row_mask:0xf bank_mask:0xf
v_dot2c_f32_bf16_dpp v9, v33, v196 row_newbcast:0 row_mask:0xf bank_mask:0xf
v_dot2c_f32_bf16_dpp v10, v32, v197 row_newbcast:0 row_mask:0xf bank_mask:0xf
v_dot2c_f32_bf16_dpp v11, v33, v197 row_newbcast:0 row_mask:0xf bank_mask:0xf
v_dot2c_f32_bf16_dpp v12, v32, v198 row_newbcast:0 row_mask:0xf bank_mask:0xf
v_dot2c_f32_bf16_dpp v13, v33, v198 row_newbcast:0 row_mask:0xf bank_mask:0xf
v_dot2c_f32_bf16_dpp v14, v32, v199 row_newbcast:0 row_mask:0xf bank_mask:0xf
v_dot2c_f32_bf16_dpp v15, v33, v199 row_newbcast:0 row_mask:0xf bank_mask:0xf
v_dot2c_f32_bf16_dpp v8, v32, v200 row_newbcast:4 row_mask:0xf bank_mask:0xf
v_dot2c_f32_bf16_dpp v9, v33, v200 row_newbcast:4 row_mask:0xf bank_mask:0xf
v_dot2c_f32_bf16_dpp v10, v32, v201 row_newbcast:4 row_mask:0xf bank_mask:0xf
v_dot2c_f32_bf16_dpp v11, v33, v201 row_newbcast:4 row_mask:0xf bank_mask:0xf
v_dot2c_f32_bf16_dpp v12, v32, v202 row_newbcast:4 row_mask:0xf bank_mask:0xf
v_dot2c_f32_bf16_dpp v13, v33, v202 row_newbcast:4 row_mask:0xf bank_mask:0xf
v_dot2c_f32_bf16_dpp v14, v32, v203 row_newbcast:4 row_mask:0xf bank_mask:0xf
v_dot2c_f32_bf16_dpp v15, v33, v203 row_newbcast:4 row_mask:0xf bank_mask:0xf
v_dot2c_f32_bf16_dpp v8, v32, v204 row_newbcast:8 row_mask:0xf bank_mask:0xf
v_dot2c_f32_bf16_dpp v9, v33, v204 row_newbcast:8 row_mask:0xf bank_mask:0xf
v_dot2c_f32_bf16_dpp v10, v32, v205 row_newbcast:8 row_mask:0xf bank_mask:0xf
v_dot2c_f32_bf16_dpp v11, v33, v205 row_newbcast:8 row_mask:0xf bank_mask:0xf
v_dot2c_f32_bf16_dpp v12, v32, v206 row_newbcast:8 row_mask:0xf bank_mask:0xf
v_dot2c_f32_bf16_dpp v13, v33, v206 row_newbcast:8 row_mask:0xf bank_mask:0xf
v_dot2c_f32_bf16_dpp v14, v32, v207 row_newbcast:8 row_mask:0xf bank_mask:0xf
v_dot2c_f32_bf16_dpp v15, v33, v207 row_newbcast:8 row_mask:0xf bank_mask:0xf
v_dot2c_f32_bf16_dpp v8, v32, v208 row_newbcast:12 row_mask:0xf bank_mask:0xf
v_dot2c_f32_bf16_dpp v9, v33, v208 row_newbcast:12 row_mask:0xf bank_mask:0xf
v_dot2c_f32_bf16_dpp v10, v32, v209 row_newbcast:12 row_mask:0xf bank_mask:0xf
v_dot2c_f32_bf16_dpp v11, v33, v209 row_newbcast:12 row_mask:0xf bank_mask:0xf
v_dot2c_f32_bf16_dpp v12, v32, v210 row_newbcast:12 row_mask:0xf bank_mask:0xf
v_dot2c_f32_bf16_dpp v13, v33, v210 row_newbcast:12 row_mask:0xf bank_mask:0xf
v_dot2c_f32_bf16_dpp v14, v32, v211 row_newbcast:12 row_mask:0xf bank_mask:0xf
v_dot2c_f32_bf16_dpp v15, v33, v211 row_newbcast:12 row_mask:0xf bank_mask:0xf
s_mov_b32 s58, 655360
buffer_load_dwordx4 v[196:199], v2, s[28:31], s58 offen offset:0 nt
buffer_load_dwordx4 v[200:203], v2, s[28:31], s58 offen offset:1024 nt
buffer_load_dwordx4 v[204:207], v2, s[28:31], s58 offen offset:2048 nt
buffer_load_dwordx4 v[208:211], v2, s[28:31], s58 offen offset:3072 nt
s_mov_b32 s58, 0
buffer_load_dwordx2 v[48:49], v21, s[36:39], s58 offen offset:0
buffer_load_dwordx2 v[50:51], v21, s[36:39], s58 offen offset:1024
buffer_load_dwordx2 v[52:53], v21, s[36:39], s58 offen offset:2048
buffer_load_dwordx2 v[54:55], v21, s[36:39], s58 offen offset:3072
s_mov_b32 s58, 4096
buffer_load_dwordx2 v[56:57], v21, s[36:39], s58 offen offset:0
buffer_load_dwordx2 v[58:59], v21, s[36:39], s58 offen offset:1024
buffer_load_dwordx2 v[60:61], v21, s[36:39], s58 offen offset:2048
buffer_load_dwordx2 v[62:63], v21, s[36:39], s58 offen offset:3072
s_waitcnt vmcnt(28)
v_dot2_f32_bf16 v22, v212, v4, 0
v_dot2_f32_bf16 v23, v216, v4, 0
v_dot2_f32_bf16 v24, v220, v4, 0
v_dot2_f32_bf16 v25, v224, v4, 0
v_dot2c_f32_bf16 v22, v213, v5
v_dot2c_f32_bf16 v23, v217, v5
v_dot2c_f32_bf16 v24, v221, v5
v_dot2c_f32_bf16 v25, v225, v5
v_dot2c_f32_bf16 v22, v214, v6
v_dot2c_f32_bf16 v23, v218, v6
v_dot2c_f32_bf16 v24, v222, v6
v_dot2c_f32_bf16 v25, v226, v6
v_dot2c_f32_bf16 v22, v215, v7
v_dot2c_f32_bf16 v23, v219, v7
v_dot2c_f32_bf16 v24, v223, v7
v_dot2c_f32_bf16 v25, v227, v7
s_mov_b32 s58, 720896
buffer_load_dwordx4 v[212:215], v2, s[24:27], s58 offen offset:0 nt
buffer_load_dwordx4 v[216:219], v2, s[24:27], s58 offen offset:1024 nt
buffer_load_dwordx4 v[220:223], v2, s[24:27], s58 offen offset:2048 nt
buffer_load_dwordx4 v[224:227], v2, s[24:27], s58 offen offset:3072 nt
v_add_f32_dpp v26, v22, v22 row_ror:8 row_mask:0xf bank_mask:0x3
v_add_f32_dpp v27, v23, v23 row_ror:8 row_mask:0xf bank_mask:0x3
s_nop 0
v_add_f32_dpp v26, v24, v24 row_ror:8 row_mask:0xf bank_mask:0xc
v_add_f32_dpp v27, v25, v25 row_ror:8 row_mask:0xf bank_mask:0xc
s_nop 0
v_add_f32_dpp v28, v26, v26 row_half_mirror row_mask:0xf bank_mask:0x5
s_nop 1
v_add_f32_dpp v28, v27, v27 row_half_mirror row_mask:0xf bank_mask:0xa
s_nop 1
v_add_f32_dpp v28, v28, v28 quad_perm:[1,0,3,2] row_mask:0xf bank_mask:0xf
s_nop 1
v_add_f32_dpp v28, v28, v28 quad_perm:[2,3,0,1] row_mask:0xf bank_mask:0xf
v_cvt_pk_bf16_f32 v28, v28, v28
v_and_b32 v28, s62, v28
v_mul_f32 v28, s60, v28
v_cvt_pk_bf16_f32 v28, v28, v28
v_and_b32 v28, s62, v28
s_nop 1
v_max_f32_dpp v29, v28, v28 row_ror:8 row_mask:0xf bank_mask:0xf
s_nop 1
v_max_f32_dpp v29, v29, v29 row_ror:4 row_mask:0xf bank_mask:0xf
v_max_f32 v29, v29, v16
v_sub_f32 v30, v16, v29
v_sub_f32 v31, v28, v29
v_mov_b32 v16, v29
v_mul_f32 v30, s61, v30
v_mul_f32 v31, s61, v31
v_exp_f32 v30, v30
v_exp_f32 v31, v31
s_nop 0
v_fma_f32 v17, v17, v30, v31
v_cvt_pk_bf16_f32 v32, v31, 0
v_cvt_pk_bf16_f32 v33, 0, v31
v_mul_f32 v8, v8, v30
v_mul_f32 v9, v9, v30
v_mul_f32 v10, v10, v30
v_mul_f32 v11, v11, v30
v_mul_f32 v12, v12, v30
v_mul_f32 v13, v13, v30
v_mul_f32 v14, v14, v30
v_mul_f32 v15, v15, v30
s_waitcnt vmcnt(28)
v_dot2c_f32_bf16_dpp v8, v32, v228 row_newbcast:0 row_mask:0xf bank_mask:0xf
v_dot2c_f32_bf16_dpp v9, v33, v228 row_newbcast:0 row_mask:0xf bank_mask:0xf
v_dot2c_f32_bf16_dpp v10, v32, v229 row_newbcast:0 row_mask:0xf bank_mask:0xf
v_dot2c_f32_bf16_dpp v11, v33, v229 row_newbcast:0 row_mask:0xf bank_mask:0xf
v_dot2c_f32_bf16_dpp v12, v32, v230 row_newbcast:0 row_mask:0xf bank_mask:0xf
v_dot2c_f32_bf16_dpp v13, v33, v230 row_newbcast:0 row_mask:0xf bank_mask:0xf
v_dot2c_f32_bf16_dpp v14, v32, v231 row_newbcast:0 row_mask:0xf bank_mask:0xf
v_dot2c_f32_bf16_dpp v15, v33, v231 row_newbcast:0 row_mask:0xf bank_mask:0xf
v_dot2c_f32_bf16_dpp v8, v32, v232 row_newbcast:4 row_mask:0xf bank_mask:0xf
v_dot2c_f32_bf16_dpp v9, v33, v232 row_newbcast:4 row_mask:0xf bank_mask:0xf
v_dot2c_f32_bf16_dpp v10, v32, v233 row_newbcast:4 row_mask:0xf bank_mask:0xf
v_dot2c_f32_bf16_dpp v11, v33, v233 row_newbcast:4 row_mask:0xf bank_mask:0xf
v_dot2c_f32_bf16_dpp v12, v32, v234 row_newbcast:4 row_mask:0xf bank_mask:0xf
v_dot2c_f32_bf16_dpp v13, v33, v234 row_newbcast:4 row_mask:0xf bank_mask:0xf
v_dot2c_f32_bf16_dpp v14, v32, v235 row_newbcast:4 row_mask:0xf bank_mask:0xf
v_dot2c_f32_bf16_dpp v15, v33, v235 row_newbcast:4 row_mask:0xf bank_mask:0xf
v_dot2c_f32_bf16_dpp v8, v32, v236 row_newbcast:8 row_mask:0xf bank_mask:0xf
v_dot2c_f32_bf16_dpp v9, v33, v236 row_newbcast:8 row_mask:0xf bank_mask:0xf
v_dot2c_f32_bf16_dpp v10, v32, v237 row_newbcast:8 row_mask:0xf bank_mask:0xf
v_dot2c_f32_bf16_dpp v11, v33, v237 row_newbcast:8 row_mask:0xf bank_mask:0xf
v_dot2c_f32_bf16_dpp v12, v32, v238 row_newbcast:8 row_mask:0xf bank_mask:0xf
v_dot2c_f32_bf16_dpp v13, v33, v238 row_newbcast:8 row_mask:0xf bank_mask:0xf
v_dot2c_f32_bf16_dpp v14, v32, v239 row_newbcast:8 row_mask:0xf bank_mask:0xf
v_dot2c_f32_bf16_dpp v15, v33, v239 row_newbcast:8 row_mask:0xf bank_mask:0xf
v_dot2c_f32_bf16_dpp v8, v32, v240 row_newbcast:12 row_mask:0xf bank_mask:0xf
v_dot2c_f32_bf16_dpp v9, v33, v240 row_newbcast:12 row_mask:0xf bank_mask:0xf
v_dot2c_f32_bf16_dpp v10, v32, v241 row_newbcast:12 row_mask:0xf bank_mask:0xf
v_dot2c_f32_bf16_dpp v11, v33, v241 row_newbcast:12 row_mask:0xf bank_mask:0xf
v_dot2c_f32_bf16_dpp v12, v32, v242 row_newbcast:12 row_mask:0xf bank_mask:0xf
v_dot2c_f32_bf16_dpp v13, v33, v242 row_newbcast:12 row_mask:0xf bank_mask:0xf
v_dot2c_f32_bf16_dpp v14, v32, v243 row_newbcast:12 row_mask:0xf bank_mask:0xf
v_dot2c_f32_bf16_dpp v15, v33, v243 row_newbcast:12 row_mask:0xf bank_mask:0xf
s_mov_b32 s58, 720896
buffer_load_dwordx4 v[228:231], v2, s[28:31], s58 offen offset:0 nt
buffer_load_dwordx4 v[232:235], v2, s[28:31], s58 offen offset:1024 nt
buffer_load_dwordx4 v[236:239], v2, s[28:31], s58 offen offset:2048 nt
buffer_load_dwordx4 v[240:243], v2, s[28:31], s58 offen offset:3072 nt
s_mov_b32 s58, 8192
buffer_load_dwordx2 v[64:65], v21, s[36:39], s58 offen offset:0
buffer_load_dwordx2 v[66:67], v21, s[36:39], s58 offen offset:1024
buffer_load_dwordx2 v[68:69], v21, s[36:39], s58 offen offset:2048
buffer_load_dwordx2 v[70:71], v21, s[36:39], s58 offen offset:3072
s_mov_b32 s58, 12288
buffer_load_dwordx2 v[72:73], v21, s[36:39], s58 offen offset:0
buffer_load_dwordx2 v[74:75], v21, s[36:39], s58 offen offset:1024
buffer_load_dwordx2 v[76:77], v21, s[36:39], s58 offen offset:2048
buffer_load_dwordx2 v[78:79], v21, s[36:39], s58 offen offset:3072
s_waitcnt vmcnt(36)
v_dot2_f32_bf16 v22, v148, v4, 0
v_dot2_f32_bf16 v23, v152, v4, 0
v_dot2_f32_bf16 v24, v156, v4, 0
v_dot2_f32_bf16 v25, v160, v4, 0
v_dot2c_f32_bf16 v22, v149, v5
v_dot2c_f32_bf16 v23, v153, v5
v_dot2c_f32_bf16 v24, v157, v5
v_dot2c_f32_bf16 v25, v161, v5
v_dot2c_f32_bf16 v22, v150, v6
v_dot2c_f32_bf16 v23, v154, v6
v_dot2c_f32_bf16 v24, v158, v6
v_dot2c_f32_bf16 v25, v162, v6
v_dot2c_f32_bf16 v22, v151, v7
v_dot2c_f32_bf16 v23, v155, v7
v_dot2c_f32_bf16 v24, v159, v7
v_dot2c_f32_bf16 v25, v163, v7
s_mov_b32 s58, 786432
buffer_load_dwordx4 v[148:151], v2, s[24:27], s58 offen offset:0 nt
buffer_load_dwordx4 v[152:155], v2, s[24:27], s58 offen offset:1024 nt
buffer_load_dwordx4 v[156:159], v2, s[24:27], s58 offen offset:2048 nt
buffer_load_dwordx4 v[160:163], v2, s[24:27], s58 offen offset:3072 nt
v_add_f32_dpp v26, v22, v22 row_ror:8 row_mask:0xf bank_mask:0x3
v_add_f32_dpp v27, v23, v23 row_ror:8 row_mask:0xf bank_mask:0x3
s_nop 0
v_add_f32_dpp v26, v24, v24 row_ror:8 row_mask:0xf bank_mask:0xc
v_add_f32_dpp v27, v25, v25 row_ror:8 row_mask:0xf bank_mask:0xc
s_nop 0
v_add_f32_dpp v28, v26, v26 row_half_mirror row_mask:0xf bank_mask:0x5
s_nop 1
v_add_f32_dpp v28, v27, v27 row_half_mirror row_mask:0xf bank_mask:0xa
s_nop 1
v_add_f32_dpp v28, v28, v28 quad_perm:[1,0,3,2] row_mask:0xf bank_mask:0xf
s_nop 1
v_add_f32_dpp v28, v28, v28 quad_perm:[2,3,0,1] row_mask:0xf bank_mask:0xf
v_cvt_pk_bf16_f32 v28, v28, v28
v_and_b32 v28, s62, v28
v_mul_f32 v28, s60, v28
v_cvt_pk_bf16_f32 v28, v28, v28
v_and_b32 v28, s62, v28
s_nop 1
v_max_f32_dpp v29, v28, v28 row_ror:8 row_mask:0xf bank_mask:0xf
s_nop 1
v_max_f32_dpp v29, v29, v29 row_ror:4 row_mask:0xf bank_mask:0xf
v_max_f32 v29, v29, v16
v_sub_f32 v30, v16, v29
v_sub_f32 v31, v28, v29
v_mov_b32 v16, v29
v_mul_f32 v30, s61, v30
v_mul_f32 v31, s61, v31
v_exp_f32 v30, v30
v_exp_f32 v31, v31
s_nop 0
v_fma_f32 v17, v17, v30, v31
v_cvt_pk_bf16_f32 v32, v31, 0
v_cvt_pk_bf16_f32 v33, 0, v31
v_mul_f32 v8, v8, v30
v_mul_f32 v9, v9, v30
v_mul_f32 v10, v10, v30
v_mul_f32 v11, v11, v30
v_mul_f32 v12, v12, v30
v_mul_f32 v13, v13, v30
v_mul_f32 v14, v14, v30
v_mul_f32 v15, v15, v30
s_waitcnt vmcnt(36)
v_dot2c_f32_bf16_dpp v8, v32, v164 row_newbcast:0 row_mask:0xf bank_mask:0xf
v_dot2c_f32_bf16_dpp v9, v33, v164 row_newbcast:0 row_mask:0xf bank_mask:0xf
v_dot2c_f32_bf16_dpp v10, v32, v165 row_newbcast:0 row_mask:0xf bank_mask:0xf
v_dot2c_f32_bf16_dpp v11, v33, v165 row_newbcast:0 row_mask:0xf bank_mask:0xf
v_dot2c_f32_bf16_dpp v12, v32, v166 row_newbcast:0 row_mask:0xf bank_mask:0xf
v_dot2c_f32_bf16_dpp v13, v33, v166 row_newbcast:0 row_mask:0xf bank_mask:0xf
v_dot2c_f32_bf16_dpp v14, v32, v167 row_newbcast:0 row_mask:0xf bank_mask:0xf
v_dot2c_f32_bf16_dpp v15, v33, v167 row_newbcast:0 row_mask:0xf bank_mask:0xf
v_dot2c_f32_bf16_dpp v8, v32, v168 row_newbcast:4 row_mask:0xf bank_mask:0xf
v_dot2c_f32_bf16_dpp v9, v33, v168 row_newbcast:4 row_mask:0xf bank_mask:0xf
v_dot2c_f32_bf16_dpp v10, v32, v169 row_newbcast:4 row_mask:0xf bank_mask:0xf
v_dot2c_f32_bf16_dpp v11, v33, v169 row_newbcast:4 row_mask:0xf bank_mask:0xf
v_dot2c_f32_bf16_dpp v12, v32, v170 row_newbcast:4 row_mask:0xf bank_mask:0xf
v_dot2c_f32_bf16_dpp v13, v33, v170 row_newbcast:4 row_mask:0xf bank_mask:0xf
v_dot2c_f32_bf16_dpp v14, v32, v171 row_newbcast:4 row_mask:0xf bank_mask:0xf
v_dot2c_f32_bf16_dpp v15, v33, v171 row_newbcast:4 row_mask:0xf bank_mask:0xf
v_dot2c_f32_bf16_dpp v8, v32, v172 row_newbcast:8 row_mask:0xf bank_mask:0xf
v_dot2c_f32_bf16_dpp v9, v33, v172 row_newbcast:8 row_mask:0xf bank_mask:0xf
v_dot2c_f32_bf16_dpp v10, v32, v173 row_newbcast:8 row_mask:0xf bank_mask:0xf
v_dot2c_f32_bf16_dpp v11, v33, v173 row_newbcast:8 row_mask:0xf bank_mask:0xf
v_dot2c_f32_bf16_dpp v12, v32, v174 row_newbcast:8 row_mask:0xf bank_mask:0xf
v_dot2c_f32_bf16_dpp v13, v33, v174 row_newbcast:8 row_mask:0xf bank_mask:0xf
v_dot2c_f32_bf16_dpp v14, v32, v175 row_newbcast:8 row_mask:0xf bank_mask:0xf
v_dot2c_f32_bf16_dpp v15, v33, v175 row_newbcast:8 row_mask:0xf bank_mask:0xf
v_dot2c_f32_bf16_dpp v8, v32, v176 row_newbcast:12 row_mask:0xf bank_mask:0xf
v_dot2c_f32_bf16_dpp v9, v33, v176 row_newbcast:12 row_mask:0xf bank_mask:0xf
v_dot2c_f32_bf16_dpp v10, v32, v177 row_newbcast:12 row_mask:0xf bank_mask:0xf
v_dot2c_f32_bf16_dpp v11, v33, v177 row_newbcast:12 row_mask:0xf bank_mask:0xf
v_dot2c_f32_bf16_dpp v12, v32, v178 row_newbcast:12 row_mask:0xf bank_mask:0xf
v_dot2c_f32_bf16_dpp v13, v33, v178 row_newbcast:12 row_mask:0xf bank_mask:0xf
v_dot2c_f32_bf16_dpp v14, v32, v179 row_newbcast:12 row_mask:0xf bank_mask:0xf
v_dot2c_f32_bf16_dpp v15, v33, v179 row_newbcast:12 row_mask:0xf bank_mask:0xf
s_mov_b32 s58, 786432
buffer_load_dwordx4 v[164:167], v2, s[28:31], s58 offen offset:0 nt
buffer_load_dwordx4 v[168:171], v2, s[28:31], s58 offen offset:1024 nt
buffer_load_dwordx4 v[172:175], v2, s[28:31], s58 offen offset:2048 nt
buffer_load_dwordx4 v[176:179], v2, s[28:31], s58 offen offset:3072 nt
s_mov_b32 s58, 16384
buffer_load_dwordx2 v[80:81], v21, s[36:39], s58 offen offset:0
buffer_load_dwordx2 v[82:83], v21, s[36:39], s58 offen offset:1024
buffer_load_dwordx2 v[84:85], v21, s[36:39], s58 offen offset:2048
buffer_load_dwordx2 v[86:87], v21, s[36:39], s58 offen offset:3072
s_mov_b32 s58, 20480
buffer_load_dwordx2 v[88:89], v21, s[36:39], s58 offen offset:0
buffer_load_dwordx2 v[90:91], v21, s[36:39], s58 offen offset:1024
buffer_load_dwordx2 v[92:93], v21, s[36:39], s58 offen offset:2048
buffer_load_dwordx2 v[94:95], v21, s[36:39], s58 offen offset:3072
s_waitcnt vmcnt(44)
v_dot2_f32_bf16 v22, v180, v4, 0
v_dot2_f32_bf16 v23, v184, v4, 0
v_dot2_f32_bf16 v24, v188, v4, 0
v_dot2_f32_bf16 v25, v192, v4, 0
v_dot2c_f32_bf16 v22, v181, v5
v_dot2c_f32_bf16 v23, v185, v5
v_dot2c_f32_bf16 v24, v189, v5
v_dot2c_f32_bf16 v25, v193, v5
v_dot2c_f32_bf16 v22, v182, v6
v_dot2c_f32_bf16 v23, v186, v6
v_dot2c_f32_bf16 v24, v190, v6
v_dot2c_f32_bf16 v25, v194, v6
v_dot2c_f32_bf16 v22, v183, v7
v_dot2c_f32_bf16 v23, v187, v7
v_dot2c_f32_bf16 v24, v191, v7
v_dot2c_f32_bf16 v25, v195, v7
s_mov_b32 s58, 851968
buffer_load_dwordx4 v[180:183], v2, s[24:27], s58 offen offset:0 nt
buffer_load_dwordx4 v[184:187], v2, s[24:27], s58 offen offset:1024 nt
buffer_load_dwordx4 v[188:191], v2, s[24:27], s58 offen offset:2048 nt
buffer_load_dwordx4 v[192:195], v2, s[24:27], s58 offen offset:3072 nt
v_add_f32_dpp v26, v22, v22 row_ror:8 row_mask:0xf bank_mask:0x3
v_add_f32_dpp v27, v23, v23 row_ror:8 row_mask:0xf bank_mask:0x3
s_nop 0
v_add_f32_dpp v26, v24, v24 row_ror:8 row_mask:0xf bank_mask:0xc
v_add_f32_dpp v27, v25, v25 row_ror:8 row_mask:0xf bank_mask:0xc
s_nop 0
v_add_f32_dpp v28, v26, v26 row_half_mirror row_mask:0xf bank_mask:0x5
s_nop 1
v_add_f32_dpp v28, v27, v27 row_half_mirror row_mask:0xf bank_mask:0xa
s_nop 1
v_add_f32_dpp v28, v28, v28 quad_perm:[1,0,3,2] row_mask:0xf bank_mask:0xf
s_nop 1
v_add_f32_dpp v28, v28, v28 quad_perm:[2,3,0,1] row_mask:0xf bank_mask:0xf
v_cvt_pk_bf16_f32 v28, v28, v28
v_and_b32 v28, s62, v28
v_mul_f32 v28, s60, v28
v_cvt_pk_bf16_f32 v28, v28, v28
v_and_b32 v28, s62, v28
s_nop 1
v_max_f32_dpp v29, v28, v28 row_ror:8 row_mask:0xf bank_mask:0xf
s_nop 1
v_max_f32_dpp v29, v29, v29 row_ror:4 row_mask:0xf bank_mask:0xf
v_max_f32 v29, v29, v16
v_sub_f32 v30, v16, v29
v_sub_f32 v31, v28, v29
v_mov_b32 v16, v29
v_mul_f32 v30, s61, v30
v_mul_f32 v31, s61, v31
v_exp_f32 v30, v30
v_exp_f32 v31, v31
s_nop 0
v_fma_f32 v17, v17, v30, v31
v_cvt_pk_bf16_f32 v32, v31, 0
v_cvt_pk_bf16_f32 v33, 0, v31
v_mul_f32 v8, v8, v30
v_mul_f32 v9, v9, v30
v_mul_f32 v10, v10, v30
v_mul_f32 v11, v11, v30
v_mul_f32 v12, v12, v30
v_mul_f32 v13, v13, v30
v_mul_f32 v14, v14, v30
v_mul_f32 v15, v15, v30
s_waitcnt vmcnt(44)
v_dot2c_f32_bf16_dpp v8, v32, v196 row_newbcast:0 row_mask:0xf bank_mask:0xf
v_dot2c_f32_bf16_dpp v9, v33, v196 row_newbcast:0 row_mask:0xf bank_mask:0xf
v_dot2c_f32_bf16_dpp v10, v32, v197 row_newbcast:0 row_mask:0xf bank_mask:0xf
v_dot2c_f32_bf16_dpp v11, v33, v197 row_newbcast:0 row_mask:0xf bank_mask:0xf
v_dot2c_f32_bf16_dpp v12, v32, v198 row_newbcast:0 row_mask:0xf bank_mask:0xf
v_dot2c_f32_bf16_dpp v13, v33, v198 row_newbcast:0 row_mask:0xf bank_mask:0xf
v_dot2c_f32_bf16_dpp v14, v32, v199 row_newbcast:0 row_mask:0xf bank_mask:0xf
v_dot2c_f32_bf16_dpp v15, v33, v199 row_newbcast:0 row_mask:0xf bank_mask:0xf
v_dot2c_f32_bf16_dpp v8, v32, v200 row_newbcast:4 row_mask:0xf bank_mask:0xf
v_dot2c_f32_bf16_dpp v9, v33, v200 row_newbcast:4 row_mask:0xf bank_mask:0xf
v_dot2c_f32_bf16_dpp v10, v32, v201 row_newbcast:4 row_mask:0xf bank_mask:0xf
v_dot2c_f32_bf16_dpp v11, v33, v201 row_newbcast:4 row_mask:0xf bank_mask:0xf
v_dot2c_f32_bf16_dpp v12, v32, v202 row_newbcast:4 row_mask:0xf bank_mask:0xf
v_dot2c_f32_bf16_dpp v13, v33, v202 row_newbcast:4 row_mask:0xf bank_mask:0xf
v_dot2c_f32_bf16_dpp v14, v32, v203 row_newbcast:4 row_mask:0xf bank_mask:0xf
v_dot2c_f32_bf16_dpp v15, v33, v203 row_newbcast:4 row_mask:0xf bank_mask:0xf
v_dot2c_f32_bf16_dpp v8, v32, v204 row_newbcast:8 row_mask:0xf bank_mask:0xf
v_dot2c_f32_bf16_dpp v9, v33, v204 row_newbcast:8 row_mask:0xf bank_mask:0xf
v_dot2c_f32_bf16_dpp v10, v32, v205 row_newbcast:8 row_mask:0xf bank_mask:0xf
v_dot2c_f32_bf16_dpp v11, v33, v205 row_newbcast:8 row_mask:0xf bank_mask:0xf
v_dot2c_f32_bf16_dpp v12, v32, v206 row_newbcast:8 row_mask:0xf bank_mask:0xf
v_dot2c_f32_bf16_dpp v13, v33, v206 row_newbcast:8 row_mask:0xf bank_mask:0xf
v_dot2c_f32_bf16_dpp v14, v32, v207 row_newbcast:8 row_mask:0xf bank_mask:0xf
v_dot2c_f32_bf16_dpp v15, v33, v207 row_newbcast:8 row_mask:0xf bank_mask:0xf
v_dot2c_f32_bf16_dpp v8, v32, v208 row_newbcast:12 row_mask:0xf bank_mask:0xf
v_dot2c_f32_bf16_dpp v9, v33, v208 row_newbcast:12 row_mask:0xf bank_mask:0xf
v_dot2c_f32_bf16_dpp v10, v32, v209 row_newbcast:12 row_mask:0xf bank_mask:0xf
v_dot2c_f32_bf16_dpp v11, v33, v209 row_newbcast:12 row_mask:0xf bank_mask:0xf
v_dot2c_f32_bf16_dpp v12, v32, v210 row_newbcast:12 row_mask:0xf bank_mask:0xf
v_dot2c_f32_bf16_dpp v13, v33, v210 row_newbcast:12 row_mask:0xf bank_mask:0xf
v_dot2c_f32_bf16_dpp v14, v32, v211 row_newbcast:12 row_mask:0xf bank_mask:0xf
v_dot2c_f32_bf16_dpp v15, v33, v211 row_newbcast:12 row_mask:0xf bank_mask:0xf
s_mov_b32 s58, 851968
buffer_load_dwordx4 v[196:199], v2, s[28:31], s58 offen offset:0 nt
buffer_load_dwordx4 v[200:203], v2, s[28:31], s58 offen offset:1024 nt
buffer_load_dwordx4 v[204:207], v2, s[28:31], s58 offen offset:2048 nt
buffer_load_dwordx4 v[208:211], v2, s[28:31], s58 offen offset:3072 nt
s_mov_b32 s58, 24576
buffer_load_dwordx2 v[96:97], v21, s[36:39], s58 offen offset:0
buffer_load_dwordx2 v[98:99], v21, s[36:39], s58 offen offset:1024
buffer_load_dwordx2 v[100:101], v21, s[36:39], s58 offen offset:2048
buffer_load_dwordx2 v[102:103], v21, s[36:39], s58 offen offset:3072
s_mov_b32 s58, 28672
buffer_load_dwordx2 v[104:105], v21, s[36:39], s58 offen offset:0
buffer_load_dwordx2 v[106:107], v21, s[36:39], s58 offen offset:1024
buffer_load_dwordx2 v[108:109], v21, s[36:39], s58 offen offset:2048
buffer_load_dwordx2 v[110:111], v21, s[36:39], s58 offen offset:3072
s_waitcnt vmcnt(44)
v_dot2_f32_bf16 v22, v212, v4, 0
v_dot2_f32_bf16 v23, v216, v4, 0
v_dot2_f32_bf16 v24, v220, v4, 0
v_dot2_f32_bf16 v25, v224, v4, 0
v_dot2c_f32_bf16 v22, v213, v5
v_dot2c_f32_bf16 v23, v217, v5
v_dot2c_f32_bf16 v24, v221, v5
v_dot2c_f32_bf16 v25, v225, v5
v_dot2c_f32_bf16 v22, v214, v6
v_dot2c_f32_bf16 v23, v218, v6
v_dot2c_f32_bf16 v24, v222, v6
v_dot2c_f32_bf16 v25, v226, v6
v_dot2c_f32_bf16 v22, v215, v7
v_dot2c_f32_bf16 v23, v219, v7
v_dot2c_f32_bf16 v24, v223, v7
v_dot2c_f32_bf16 v25, v227, v7
s_mov_b32 s58, 917504
buffer_load_dwordx4 v[212:215], v2, s[24:27], s58 offen offset:0 nt
buffer_load_dwordx4 v[216:219], v2, s[24:27], s58 offen offset:1024 nt
buffer_load_dwordx4 v[220:223], v2, s[24:27], s58 offen offset:2048 nt
buffer_load_dwordx4 v[224:227], v2, s[24:27], s58 offen offset:3072 nt
v_add_f32_dpp v26, v22, v22 row_ror:8 row_mask:0xf bank_mask:0x3
v_add_f32_dpp v27, v23, v23 row_ror:8 row_mask:0xf bank_mask:0x3
s_nop 0
v_add_f32_dpp v26, v24, v24 row_ror:8 row_mask:0xf bank_mask:0xc
v_add_f32_dpp v27, v25, v25 row_ror:8 row_mask:0xf bank_mask:0xc
s_nop 0
v_add_f32_dpp v28, v26, v26 row_half_mirror row_mask:0xf bank_mask:0x5
s_nop 1
v_add_f32_dpp v28, v27, v27 row_half_mirror row_mask:0xf bank_mask:0xa
s_nop 1
v_add_f32_dpp v28, v28, v28 quad_perm:[1,0,3,2] row_mask:0xf bank_mask:0xf
s_nop 1
v_add_f32_dpp v28, v28, v28 quad_perm:[2,3,0,1] row_mask:0xf bank_mask:0xf
v_cvt_pk_bf16_f32 v28, v28, v28
v_and_b32 v28, s62, v28
v_mul_f32 v28, s60, v28
v_cvt_pk_bf16_f32 v28, v28, v28
v_and_b32 v28, s62, v28
s_nop 1
v_max_f32_dpp v29, v28, v28 row_ror:8 row_mask:0xf bank_mask:0xf
s_nop 1
v_max_f32_dpp v29, v29, v29 row_ror:4 row_mask:0xf bank_mask:0xf
v_max_f32 v29, v29, v16
v_sub_f32 v30, v16, v29
v_sub_f32 v31, v28, v29
v_mov_b32 v16, v29
v_mul_f32 v30, s61, v30
v_mul_f32 v31, s61, v31
v_exp_f32 v30, v30
v_exp_f32 v31, v31
s_nop 0
v_fma_f32 v17, v17, v30, v31
v_cvt_pk_bf16_f32 v32, v31, 0
v_cvt_pk_bf16_f32 v33, 0, v31
v_mul_f32 v8, v8, v30
v_mul_f32 v9, v9, v30
v_mul_f32 v10, v10, v30
v_mul_f32 v11, v11, v30
v_mul_f32 v12, v12, v30
v_mul_f32 v13, v13, v30
v_mul_f32 v14, v14, v30
v_mul_f32 v15, v15, v30
s_waitcnt vmcnt(44)
v_dot2c_f32_bf16_dpp v8, v32, v228 row_newbcast:0 row_mask:0xf bank_mask:0xf
v_dot2c_f32_bf16_dpp v9, v33, v228 row_newbcast:0 row_mask:0xf bank_mask:0xf
v_dot2c_f32_bf16_dpp v10, v32, v229 row_newbcast:0 row_mask:0xf bank_mask:0xf
v_dot2c_f32_bf16_dpp v11, v33, v229 row_newbcast:0 row_mask:0xf bank_mask:0xf
v_dot2c_f32_bf16_dpp v12, v32, v230 row_newbcast:0 row_mask:0xf bank_mask:0xf
v_dot2c_f32_bf16_dpp v13, v33, v230 row_newbcast:0 row_mask:0xf bank_mask:0xf
v_dot2c_f32_bf16_dpp v14, v32, v231 row_newbcast:0 row_mask:0xf bank_mask:0xf
v_dot2c_f32_bf16_dpp v15, v33, v231 row_newbcast:0 row_mask:0xf bank_mask:0xf
v_dot2c_f32_bf16_dpp v8, v32, v232 row_newbcast:4 row_mask:0xf bank_mask:0xf
v_dot2c_f32_bf16_dpp v9, v33, v232 row_newbcast:4 row_mask:0xf bank_mask:0xf
v_dot2c_f32_bf16_dpp v10, v32, v233 row_newbcast:4 row_mask:0xf bank_mask:0xf
v_dot2c_f32_bf16_dpp v11, v33, v233 row_newbcast:4 row_mask:0xf bank_mask:0xf
v_dot2c_f32_bf16_dpp v12, v32, v234 row_newbcast:4 row_mask:0xf bank_mask:0xf
v_dot2c_f32_bf16_dpp v13, v33, v234 row_newbcast:4 row_mask:0xf bank_mask:0xf
v_dot2c_f32_bf16_dpp v14, v32, v235 row_newbcast:4 row_mask:0xf bank_mask:0xf
v_dot2c_f32_bf16_dpp v15, v33, v235 row_newbcast:4 row_mask:0xf bank_mask:0xf
v_dot2c_f32_bf16_dpp v8, v32, v236 row_newbcast:8 row_mask:0xf bank_mask:0xf
v_dot2c_f32_bf16_dpp v9, v33, v236 row_newbcast:8 row_mask:0xf bank_mask:0xf
v_dot2c_f32_bf16_dpp v10, v32, v237 row_newbcast:8 row_mask:0xf bank_mask:0xf
v_dot2c_f32_bf16_dpp v11, v33, v237 row_newbcast:8 row_mask:0xf bank_mask:0xf
v_dot2c_f32_bf16_dpp v12, v32, v238 row_newbcast:8 row_mask:0xf bank_mask:0xf
v_dot2c_f32_bf16_dpp v13, v33, v238 row_newbcast:8 row_mask:0xf bank_mask:0xf
v_dot2c_f32_bf16_dpp v14, v32, v239 row_newbcast:8 row_mask:0xf bank_mask:0xf
v_dot2c_f32_bf16_dpp v15, v33, v239 row_newbcast:8 row_mask:0xf bank_mask:0xf
v_dot2c_f32_bf16_dpp v8, v32, v240 row_newbcast:12 row_mask:0xf bank_mask:0xf
v_dot2c_f32_bf16_dpp v9, v33, v240 row_newbcast:12 row_mask:0xf bank_mask:0xf
v_dot2c_f32_bf16_dpp v10, v32, v241 row_newbcast:12 row_mask:0xf bank_mask:0xf
v_dot2c_f32_bf16_dpp v11, v33, v241 row_newbcast:12 row_mask:0xf bank_mask:0xf
v_dot2c_f32_bf16_dpp v12, v32, v242 row_newbcast:12 row_mask:0xf bank_mask:0xf
v_dot2c_f32_bf16_dpp v13, v33, v242 row_newbcast:12 row_mask:0xf bank_mask:0xf
v_dot2c_f32_bf16_dpp v14, v32, v243 row_newbcast:12 row_mask:0xf bank_mask:0xf
v_dot2c_f32_bf16_dpp v15, v33, v243 row_newbcast:12 row_mask:0xf bank_mask:0xf
s_mov_b32 s58, 917504
buffer_load_dwordx4 v[228:231], v2, s[28:31], s58 offen offset:0 nt
buffer_load_dwordx4 v[232:235], v2, s[28:31], s58 offen offset:1024 nt
buffer_load_dwordx4 v[236:239], v2, s[28:31], s58 offen offset:2048 nt
buffer_load_dwordx4 v[240:243], v2, s[28:31], s58 offen offset:3072 nt
s_waitcnt vmcnt(36)
v_dot2_f32_bf16 v22, v148, v4, 0
v_dot2_f32_bf16 v23, v152, v4, 0
v_dot2_f32_bf16 v24, v156, v4, 0
v_dot2_f32_bf16 v25, v160, v4, 0
v_dot2c_f32_bf16 v22, v149, v5
v_dot2c_f32_bf16 v23, v153, v5
v_dot2c_f32_bf16 v24, v157, v5
v_dot2c_f32_bf16 v25, v161, v5
v_dot2c_f32_bf16 v22, v150, v6
v_dot2c_f32_bf16 v23, v154, v6
v_dot2c_f32_bf16 v24, v158, v6
v_dot2c_f32_bf16 v25, v162, v6
v_dot2c_f32_bf16 v22, v151, v7
v_dot2c_f32_bf16 v23, v155, v7
v_dot2c_f32_bf16 v24, v159, v7
v_dot2c_f32_bf16 v25, v163, v7
s_mov_b32 s58, 983040
buffer_load_dwordx4 v[148:151], v2, s[24:27], s58 offen offset:0 nt
buffer_load_dwordx4 v[152:155], v2, s[24:27], s58 offen offset:1024 nt
buffer_load_dwordx4 v[156:159], v2, s[24:27], s58 offen offset:2048 nt
buffer_load_dwordx4 v[160:163], v2, s[24:27], s58 offen offset:3072 nt
v_add_f32_dpp v26, v22, v22 row_ror:8 row_mask:0xf bank_mask:0x3
v_add_f32_dpp v27, v23, v23 row_ror:8 row_mask:0xf bank_mask:0x3
s_nop 0
v_add_f32_dpp v26, v24, v24 row_ror:8 row_mask:0xf bank_mask:0xc
v_add_f32_dpp v27, v25, v25 row_ror:8 row_mask:0xf bank_mask:0xc
s_nop 0
v_add_f32_dpp v28, v26, v26 row_half_mirror row_mask:0xf bank_mask:0x5
s_nop 1
v_add_f32_dpp v28, v27, v27 row_half_mirror row_mask:0xf bank_mask:0xa
s_nop 1
v_add_f32_dpp v28, v28, v28 quad_perm:[1,0,3,2] row_mask:0xf bank_mask:0xf
s_nop 1
v_add_f32_dpp v28, v28, v28 quad_perm:[2,3,0,1] row_mask:0xf bank_mask:0xf
v_cvt_pk_bf16_f32 v28, v28, v28
v_and_b32 v28, s62, v28
v_mul_f32 v28, s60, v28
v_cvt_pk_bf16_f32 v28, v28, v28
v_and_b32 v28, s62, v28
s_nop 1
v_max_f32_dpp v29, v28, v28 row_ror:8 row_mask:0xf bank_mask:0xf
s_nop 1
v_max_f32_dpp v29, v29, v29 row_ror:4 row_mask:0xf bank_mask:0xf
v_max_f32 v29, v29, v16
v_sub_f32 v30, v16, v29
v_sub_f32 v31, v28, v29
v_mov_b32 v16, v29
v_mul_f32 v30, s61, v30
v_mul_f32 v31, s61, v31
v_exp_f32 v30, v30
v_exp_f32 v31, v31
s_nop 0
v_fma_f32 v17, v17, v30, v31
v_cvt_pk_bf16_f32 v32, v31, 0
v_cvt_pk_bf16_f32 v33, 0, v31
v_mul_f32 v8, v8, v30
v_mul_f32 v9, v9, v30
v_mul_f32 v10, v10, v30
v_mul_f32 v11, v11, v30
v_mul_f32 v12, v12, v30
v_mul_f32 v13, v13, v30
v_mul_f32 v14, v14, v30
v_mul_f32 v15, v15, v30
s_waitcnt vmcnt(36)
v_dot2c_f32_bf16_dpp v8, v32, v164 row_newbcast:0 row_mask:0xf bank_mask:0xf
v_dot2c_f32_bf16_dpp v9, v33, v164 row_newbcast:0 row_mask:0xf bank_mask:0xf
v_dot2c_f32_bf16_dpp v10, v32, v165 row_newbcast:0 row_mask:0xf bank_mask:0xf
v_dot2c_f32_bf16_dpp v11, v33, v165 row_newbcast:0 row_mask:0xf bank_mask:0xf
v_dot2c_f32_bf16_dpp v12, v32, v166 row_newbcast:0 row_mask:0xf bank_mask:0xf
v_dot2c_f32_bf16_dpp v13, v33, v166 row_newbcast:0 row_mask:0xf bank_mask:0xf
v_dot2c_f32_bf16_dpp v14, v32, v167 row_newbcast:0 row_mask:0xf bank_mask:0xf
v_dot2c_f32_bf16_dpp v15, v33, v167 row_newbcast:0 row_mask:0xf bank_mask:0xf
v_dot2c_f32_bf16_dpp v8, v32, v168 row_newbcast:4 row_mask:0xf bank_mask:0xf
v_dot2c_f32_bf16_dpp v9, v33, v168 row_newbcast:4 row_mask:0xf bank_mask:0xf
v_dot2c_f32_bf16_dpp v10, v32, v169 row_newbcast:4 row_mask:0xf bank_mask:0xf
v_dot2c_f32_bf16_dpp v11, v33, v169 row_newbcast:4 row_mask:0xf bank_mask:0xf
v_dot2c_f32_bf16_dpp v12, v32, v170 row_newbcast:4 row_mask:0xf bank_mask:0xf
v_dot2c_f32_bf16_dpp v13, v33, v170 row_newbcast:4 row_mask:0xf bank_mask:0xf
v_dot2c_f32_bf16_dpp v14, v32, v171 row_newbcast:4 row_mask:0xf bank_mask:0xf
v_dot2c_f32_bf16_dpp v15, v33, v171 row_newbcast:4 row_mask:0xf bank_mask:0xf
v_dot2c_f32_bf16_dpp v8, v32, v172 row_newbcast:8 row_mask:0xf bank_mask:0xf
v_dot2c_f32_bf16_dpp v9, v33, v172 row_newbcast:8 row_mask:0xf bank_mask:0xf
v_dot2c_f32_bf16_dpp v10, v32, v173 row_newbcast:8 row_mask:0xf bank_mask:0xf
v_dot2c_f32_bf16_dpp v11, v33, v173 row_newbcast:8 row_mask:0xf bank_mask:0xf
v_dot2c_f32_bf16_dpp v12, v32, v174 row_newbcast:8 row_mask:0xf bank_mask:0xf
v_dot2c_f32_bf16_dpp v13, v33, v174 row_newbcast:8 row_mask:0xf bank_mask:0xf
v_dot2c_f32_bf16_dpp v14, v32, v175 row_newbcast:8 row_mask:0xf bank_mask:0xf
v_dot2c_f32_bf16_dpp v15, v33, v175 row_newbcast:8 row_mask:0xf bank_mask:0xf
v_dot2c_f32_bf16_dpp v8, v32, v176 row_newbcast:12 row_mask:0xf bank_mask:0xf
v_dot2c_f32_bf16_dpp v9, v33, v176 row_newbcast:12 row_mask:0xf bank_mask:0xf
v_dot2c_f32_bf16_dpp v10, v32, v177 row_newbcast:12 row_mask:0xf bank_mask:0xf
v_dot2c_f32_bf16_dpp v11, v33, v177 row_newbcast:12 row_mask:0xf bank_mask:0xf
v_dot2c_f32_bf16_dpp v12, v32, v178 row_newbcast:12 row_mask:0xf bank_mask:0xf
v_dot2c_f32_bf16_dpp v13, v33, v178 row_newbcast:12 row_mask:0xf bank_mask:0xf
v_dot2c_f32_bf16_dpp v14, v32, v179 row_newbcast:12 row_mask:0xf bank_mask:0xf
v_dot2c_f32_bf16_dpp v15, v33, v179 row_newbcast:12 row_mask:0xf bank_mask:0xf
s_mov_b32 s58, 983040
buffer_load_dwordx4 v[164:167], v2, s[28:31], s58 offen offset:0 nt
buffer_load_dwordx4 v[168:171], v2, s[28:31], s58 offen offset:1024 nt
buffer_load_dwordx4 v[172:175], v2, s[28:31], s58 offen offset:2048 nt
buffer_load_dwordx4 v[176:179], v2, s[28:31], s58 offen offset:3072 nt
s_waitcnt vmcnt(28)
v_dot2_f32_bf16 v22, v180, v4, 0
v_dot2_f32_bf16 v23, v184, v4, 0
v_dot2_f32_bf16 v24, v188, v4, 0
v_dot2_f32_bf16 v25, v192, v4, 0
v_dot2c_f32_bf16 v22, v181, v5
v_dot2c_f32_bf16 v23, v185, v5
v_dot2c_f32_bf16 v24, v189, v5
v_dot2c_f32_bf16 v25, v193, v5
v_dot2c_f32_bf16 v22, v182, v6
v_dot2c_f32_bf16 v23, v186, v6
v_dot2c_f32_bf16 v24, v190, v6
v_dot2c_f32_bf16 v25, v194, v6
v_dot2c_f32_bf16 v22, v183, v7
v_dot2c_f32_bf16 v23, v187, v7
v_dot2c_f32_bf16 v24, v191, v7
v_dot2c_f32_bf16 v25, v195, v7
v_add_f32_dpp v26, v22, v22 row_ror:8 row_mask:0xf bank_mask:0x3
v_add_f32_dpp v27, v23, v23 row_ror:8 row_mask:0xf bank_mask:0x3
s_nop 0
v_add_f32_dpp v26, v24, v24 row_ror:8 row_mask:0xf bank_mask:0xc
v_add_f32_dpp v27, v25, v25 row_ror:8 row_mask:0xf bank_mask:0xc
s_nop 0
v_add_f32_dpp v28, v26, v26 row_half_mirror row_mask:0xf bank_mask:0x5
s_nop 1
v_add_f32_dpp v28, v27, v27 row_half_mirror row_mask:0xf bank_mask:0xa
s_nop 1
v_add_f32_dpp v28, v28, v28 quad_perm:[1,0,3,2] row_mask:0xf bank_mask:0xf
s_nop 1
v_add_f32_dpp v28, v28, v28 quad_perm:[2,3,0,1] row_mask:0xf bank_mask:0xf
v_cvt_pk_bf16_f32 v28, v28, v28
v_and_b32 v28, s62, v28
v_mul_f32 v28, s60, v28
v_cvt_pk_bf16_f32 v28, v28, v28
v_and_b32 v28, s62, v28
s_nop 1
v_max_f32_dpp v29, v28, v28 row_ror:8 row_mask:0xf bank_mask:0xf
s_nop 1
v_max_f32_dpp v29, v29, v29 row_ror:4 row_mask:0xf bank_mask:0xf
v_max_f32 v29, v29, v16
v_sub_f32 v30, v16, v29
v_sub_f32 v31, v28, v29
v_mov_b32 v16, v29
v_mul_f32 v30, s61, v30
v_mul_f32 v31, s61, v31
v_exp_f32 v30, v30
v_exp_f32 v31, v31
s_nop 0
v_fma_f32 v17, v17, v30, v31
v_cvt_pk_bf16_f32 v32, v31, 0
v_cvt_pk_bf16_f32 v33, 0, v31
v_mul_f32 v8, v8, v30
v_mul_f32 v9, v9, v30
v_mul_f32 v10, v10, v30
v_mul_f32 v11, v11, v30
v_mul_f32 v12, v12, v30
v_mul_f32 v13, v13, v30
v_mul_f32 v14, v14, v30
v_mul_f32 v15, v15, v30
s_waitcnt vmcnt(24)
v_dot2c_f32_bf16_dpp v8, v32, v196 row_newbcast:0 row_mask:0xf bank_mask:0xf
v_dot2c_f32_bf16_dpp v9, v33, v196 row_newbcast:0 row_mask:0xf bank_mask:0xf
v_dot2c_f32_bf16_dpp v10, v32, v197 row_newbcast:0 row_mask:0xf bank_mask:0xf
v_dot2c_f32_bf16_dpp v11, v33, v197 row_newbcast:0 row_mask:0xf bank_mask:0xf
v_dot2c_f32_bf16_dpp v12, v32, v198 row_newbcast:0 row_mask:0xf bank_mask:0xf
v_dot2c_f32_bf16_dpp v13, v33, v198 row_newbcast:0 row_mask:0xf bank_mask:0xf
v_dot2c_f32_bf16_dpp v14, v32, v199 row_newbcast:0 row_mask:0xf bank_mask:0xf
v_dot2c_f32_bf16_dpp v15, v33, v199 row_newbcast:0 row_mask:0xf bank_mask:0xf
v_dot2c_f32_bf16_dpp v8, v32, v200 row_newbcast:4 row_mask:0xf bank_mask:0xf
v_dot2c_f32_bf16_dpp v9, v33, v200 row_newbcast:4 row_mask:0xf bank_mask:0xf
v_dot2c_f32_bf16_dpp v10, v32, v201 row_newbcast:4 row_mask:0xf bank_mask:0xf
v_dot2c_f32_bf16_dpp v11, v33, v201 row_newbcast:4 row_mask:0xf bank_mask:0xf
v_dot2c_f32_bf16_dpp v12, v32, v202 row_newbcast:4 row_mask:0xf bank_mask:0xf
v_dot2c_f32_bf16_dpp v13, v33, v202 row_newbcast:4 row_mask:0xf bank_mask:0xf
v_dot2c_f32_bf16_dpp v14, v32, v203 row_newbcast:4 row_mask:0xf bank_mask:0xf
v_dot2c_f32_bf16_dpp v15, v33, v203 row_newbcast:4 row_mask:0xf bank_mask:0xf
v_dot2c_f32_bf16_dpp v8, v32, v204 row_newbcast:8 row_mask:0xf bank_mask:0xf
v_dot2c_f32_bf16_dpp v9, v33, v204 row_newbcast:8 row_mask:0xf bank_mask:0xf
v_dot2c_f32_bf16_dpp v10, v32, v205 row_newbcast:8 row_mask:0xf bank_mask:0xf
v_dot2c_f32_bf16_dpp v11, v33, v205 row_newbcast:8 row_mask:0xf bank_mask:0xf
v_dot2c_f32_bf16_dpp v12, v32, v206 row_newbcast:8 row_mask:0xf bank_mask:0xf
v_dot2c_f32_bf16_dpp v13, v33, v206 row_newbcast:8 row_mask:0xf bank_mask:0xf
v_dot2c_f32_bf16_dpp v14, v32, v207 row_newbcast:8 row_mask:0xf bank_mask:0xf
v_dot2c_f32_bf16_dpp v15, v33, v207 row_newbcast:8 row_mask:0xf bank_mask:0xf
v_dot2c_f32_bf16_dpp v8, v32, v208 row_newbcast:12 row_mask:0xf bank_mask:0xf
v_dot2c_f32_bf16_dpp v9, v33, v208 row_newbcast:12 row_mask:0xf bank_mask:0xf
v_dot2c_f32_bf16_dpp v10, v32, v209 row_newbcast:12 row_mask:0xf bank_mask:0xf
v_dot2c_f32_bf16_dpp v11, v33, v209 row_newbcast:12 row_mask:0xf bank_mask:0xf
v_dot2c_f32_bf16_dpp v12, v32, v210 row_newbcast:12 row_mask:0xf bank_mask:0xf
v_dot2c_f32_bf16_dpp v13, v33, v210 row_newbcast:12 row_mask:0xf bank_mask:0xf
v_dot2c_f32_bf16_dpp v14, v32, v211 row_newbcast:12 row_mask:0xf bank_mask:0xf
v_dot2c_f32_bf16_dpp v15, v33, v211 row_newbcast:12 row_mask:0xf bank_mask:0xf
s_waitcnt vmcnt(16)
v_perm_b32 v112, v50, v48, s68
v_perm_b32 v50, v50, v48, s69
v_perm_b32 v48, v51, v49, s68
v_perm_b32 v51, v51, v49, s69
v_perm_b32 v49, v54, v52, s68
v_perm_b32 v54, v54, v52, s69
v_perm_b32 v52, v55, v53, s68
v_perm_b32 v55, v55, v53, s69
v_perm_b32 v53, v58, v56, s68
v_perm_b32 v58, v58, v56, s69
v_perm_b32 v56, v59, v57, s68
v_perm_b32 v59, v59, v57, s69
v_perm_b32 v57, v62, v60, s68
v_perm_b32 v62, v62, v60, s69
v_perm_b32 v60, v63, v61, s68
v_perm_b32 v63, v63, v61, s69
v_perm_b32 v61, v66, v64, s68
v_perm_b32 v66, v66, v64, s69
v_perm_b32 v64, v67, v65, s68
v_perm_b32 v67, v67, v65, s69
v_perm_b32 v65, v70, v68, s68
v_perm_b32 v70, v70, v68, s69
v_perm_b32 v68, v71, v69, s68
v_perm_b32 v71, v71, v69, s69
v_perm_b32 v69, v74, v72, s68
v_perm_b32 v74, v74, v72, s69
v_perm_b32 v72, v75, v73, s68
v_perm_b32 v75, v75, v73, s69
v_perm_b32 v73, v78, v76, s68
v_perm_b32 v78, v78, v76, s69
v_perm_b32 v76, v79, v77, s68
v_perm_b32 v79, v79, v77, s69
v_perm_b32 v77, v82, v80, s68
v_perm_b32 v82, v82, v80, s69
v_perm_b32 v80, v83, v81, s68
v_perm_b32 v83, v83, v81, s69
v_perm_b32 v81, v86, v84, s68
v_perm_b32 v86, v86, v84, s69
v_perm_b32 v84, v87, v85, s68
v_perm_b32 v87, v87, v85, s69
v_perm_b32 v85, v90, v88, s68
v_perm_b32 v90, v90, v88, s69
v_perm_b32 v88, v91, v89, s68
v_perm_b32 v91, v91, v89, s69
v_perm_b32 v89, v94, v92, s68
v_perm_b32 v94, v94, v92, s69
v_perm_b32 v92, v95, v93, s68
v_perm_b32 v95, v95, v93, s69
v_perm_b32 v93, v98, v96, s68
v_perm_b32 v98, v98, v96, s69
v_perm_b32 v96, v99, v97, s68
v_perm_b32 v99, v99, v97, s69
v_perm_b32 v97, v102, v100, s68
v_perm_b32 v102, v102, v100, s69
v_perm_b32 v100, v103, v101, s68
v_perm_b32 v103, v103, v101, s69
v_perm_b32 v101, v106, v104, s68
v_perm_b32 v106, v106, v104, s69
v_perm_b32 v104, v107, v105, s68
v_perm_b32 v107, v107, v105, s69
v_perm_b32 v105, v110, v108, s68
v_perm_b32 v110, v110, v108, s69
v_perm_b32 v108, v111, v109, s68
v_perm_b32 v111, v111, v109, s69
v_lshlrev_b32 v116, 3, v1
v_and_b32 v117, 7, v1
v_lshlrev_b32 v122, 5, v117
v_lshlrev_b32 v117, 3, v117
s_lshl_b32 s59, s48, 9
v_add_u32 v118, s59, v20
s_lshl_b32 s59, s48, 3
v_mov_b32 v119, s59
s_and_b32 s59, s48, 3
s_lshl_b32 s59, s59, 4
s_lshl_b32 s65, s53, 6
s_add_u32 s59, s59, s65
s_lshl_b32 s59, s59, 12
s_lshl_b32 s65, s56, 6
s_add_u32 s59, s59, s65
s_lshr_b32 s65, s48, 2
s_mul_i32 s65, s65, 2031616
s_add_u32 s59, s59, s65
s_add_u32 s59, s59, 65536
v_lshrrev_b32 v120, 2, v1
v_lshlrev_b32 v120, 12, v120
v_and_b32 v27, 3, v1
v_lshl_add_u32 v120, v27, 4, v120
v_add_u32 v120, s59, v120
v_add_u32 v115, 65536, v115
v_lshlrev_b32 v121, 1, v27
v_lshrrev_b32 v27, 5, v1
v_add_u32 v121, v121, v27
v_lshlrev_b32 v121, 5, v121
s_lshl_b32 s59, s48, 2
v_add_u32 v121, s59, v121
s_lshl_b32 s59, s53, 10
s_lshl_b32 s65, s56, 4
s_add_u32 s59, s59, s65
v_lshlrev_b32 v123, 1, v1
v_add_u32 v123, s59, v123
v_and_b32 v27, 28, v1
v_cmp_eq_u32 s[14:15], 0, v27
v_cmp_gt_u32 s[16:17], 32, v1
s_waitcnt vmcnt(12)
v_dot2_f32_bf16 v22, v212, v4, 0
v_dot2_f32_bf16 v23, v216, v4, 0
v_dot2_f32_bf16 v24, v220, v4, 0
v_dot2_f32_bf16 v25, v224, v4, 0
v_dot2c_f32_bf16 v22, v213, v5
v_dot2c_f32_bf16 v23, v217, v5
v_dot2c_f32_bf16 v24, v221, v5
v_dot2c_f32_bf16 v25, v225, v5
v_dot2c_f32_bf16 v22, v214, v6
v_dot2c_f32_bf16 v23, v218, v6
v_dot2c_f32_bf16 v24, v222, v6
v_dot2c_f32_bf16 v25, v226, v6
v_dot2c_f32_bf16 v22, v215, v7
v_dot2c_f32_bf16 v23, v219, v7
v_dot2c_f32_bf16 v24, v223, v7
v_dot2c_f32_bf16 v25, v227, v7
v_add_f32_dpp v26, v22, v22 row_ror:8 row_mask:0xf bank_mask:0x3
v_add_f32_dpp v27, v23, v23 row_ror:8 row_mask:0xf bank_mask:0x3
s_nop 0
v_add_f32_dpp v26, v24, v24 row_ror:8 row_mask:0xf bank_mask:0xc
v_add_f32_dpp v27, v25, v25 row_ror:8 row_mask:0xf bank_mask:0xc
s_nop 0
v_add_f32_dpp v28, v26, v26 row_half_mirror row_mask:0xf bank_mask:0x5
s_nop 1
v_add_f32_dpp v28, v27, v27 row_half_mirror row_mask:0xf bank_mask:0xa
s_nop 1
v_add_f32_dpp v28, v28, v28 quad_perm:[1,0,3,2] row_mask:0xf bank_mask:0xf
s_nop 1
v_add_f32_dpp v28, v28, v28 quad_perm:[2,3,0,1] row_mask:0xf bank_mask:0xf
v_cvt_pk_bf16_f32 v28, v28, v28
v_and_b32 v28, s62, v28
v_mul_f32 v28, s60, v28
v_cvt_pk_bf16_f32 v28, v28, v28
v_and_b32 v28, s62, v28
s_nop 1
v_max_f32_dpp v29, v28, v28 row_ror:8 row_mask:0xf bank_mask:0xf
s_nop 1
v_max_f32_dpp v29, v29, v29 row_ror:4 row_mask:0xf bank_mask:0xf
v_max_f32 v29, v29, v16
v_sub_f32 v30, v16, v29
v_sub_f32 v31, v28, v29
v_mov_b32 v16, v29
v_mul_f32 v30, s61, v30
v_mul_f32 v31, s61, v31
v_exp_f32 v30, v30
v_exp_f32 v31, v31
s_nop 0
v_fma_f32 v17, v17, v30, v31
v_cvt_pk_bf16_f32 v32, v31, 0
v_cvt_pk_bf16_f32 v33, 0, v31
v_mul_f32 v8, v8, v30
v_mul_f32 v9, v9, v30
v_mul_f32 v10, v10, v30
v_mul_f32 v11, v11, v30
v_mul_f32 v12, v12, v30
v_mul_f32 v13, v13, v30
v_mul_f32 v14, v14, v30
v_mul_f32 v15, v15, v30
s_waitcnt vmcnt(8)
v_dot2c_f32_bf16_dpp v8, v32, v228 row_newbcast:0 row_mask:0xf bank_mask:0xf
v_dot2c_f32_bf16_dpp v9, v33, v228 row_newbcast:0 row_mask:0xf bank_mask:0xf
v_dot2c_f32_bf16_dpp v10, v32, v229 row_newbcast:0 row_mask:0xf bank_mask:0xf
v_dot2c_f32_bf16_dpp v11, v33, v229 row_newbcast:0 row_mask:0xf bank_mask:0xf
v_dot2c_f32_bf16_dpp v12, v32, v230 row_newbcast:0 row_mask:0xf bank_mask:0xf
v_dot2c_f32_bf16_dpp v13, v33, v230 row_newbcast:0 row_mask:0xf bank_mask:0xf
v_dot2c_f32_bf16_dpp v14, v32, v231 row_newbcast:0 row_mask:0xf bank_mask:0xf
v_dot2c_f32_bf16_dpp v15, v33, v231 row_newbcast:0 row_mask:0xf bank_mask:0xf
v_dot2c_f32_bf16_dpp v8, v32, v232 row_newbcast:4 row_mask:0xf bank_mask:0xf
v_dot2c_f32_bf16_dpp v9, v33, v232 row_newbcast:4 row_mask:0xf bank_mask:0xf
v_dot2c_f32_bf16_dpp v10, v32, v233 row_newbcast:4 row_mask:0xf bank_mask:0xf
v_dot2c_f32_bf16_dpp v11, v33, v233 row_newbcast:4 row_mask:0xf bank_mask:0xf
v_dot2c_f32_bf16_dpp v12, v32, v234 row_newbcast:4 row_mask:0xf bank_mask:0xf
v_dot2c_f32_bf16_dpp v13, v33, v234 row_newbcast:4 row_mask:0xf bank_mask:0xf
v_dot2c_f32_bf16_dpp v14, v32, v235 row_newbcast:4 row_mask:0xf bank_mask:0xf
v_dot2c_f32_bf16_dpp v15, v33, v235 row_newbcast:4 row_mask:0xf bank_mask:0xf
v_dot2c_f32_bf16_dpp v8, v32, v236 row_newbcast:8 row_mask:0xf bank_mask:0xf
v_dot2c_f32_bf16_dpp v9, v33, v236 row_newbcast:8 row_mask:0xf bank_mask:0xf
v_dot2c_f32_bf16_dpp v10, v32, v237 row_newbcast:8 row_mask:0xf bank_mask:0xf
v_dot2c_f32_bf16_dpp v11, v33, v237 row_newbcast:8 row_mask:0xf bank_mask:0xf
v_dot2c_f32_bf16_dpp v12, v32, v238 row_newbcast:8 row_mask:0xf bank_mask:0xf
v_dot2c_f32_bf16_dpp v13, v33, v238 row_newbcast:8 row_mask:0xf bank_mask:0xf
v_dot2c_f32_bf16_dpp v14, v32, v239 row_newbcast:8 row_mask:0xf bank_mask:0xf
v_dot2c_f32_bf16_dpp v15, v33, v239 row_newbcast:8 row_mask:0xf bank_mask:0xf
v_dot2c_f32_bf16_dpp v8, v32, v240 row_newbcast:12 row_mask:0xf bank_mask:0xf
v_dot2c_f32_bf16_dpp v9, v33, v240 row_newbcast:12 row_mask:0xf bank_mask:0xf
v_dot2c_f32_bf16_dpp v10, v32, v241 row_newbcast:12 row_mask:0xf bank_mask:0xf
v_dot2c_f32_bf16_dpp v11, v33, v241 row_newbcast:12 row_mask:0xf bank_mask:0xf
v_dot2c_f32_bf16_dpp v12, v32, v242 row_newbcast:12 row_mask:0xf bank_mask:0xf
v_dot2c_f32_bf16_dpp v13, v33, v242 row_newbcast:12 row_mask:0xf bank_mask:0xf
v_dot2c_f32_bf16_dpp v14, v32, v243 row_newbcast:12 row_mask:0xf bank_mask:0xf
v_dot2c_f32_bf16_dpp v15, v33, v243 row_newbcast:12 row_mask:0xf bank_mask:0xf
s_waitcnt vmcnt(4)
v_dot2_f32_bf16 v22, v148, v4, 0
v_dot2_f32_bf16 v23, v152, v4, 0
v_dot2_f32_bf16 v24, v156, v4, 0
v_dot2_f32_bf16 v25, v160, v4, 0
v_dot2c_f32_bf16 v22, v149, v5
v_dot2c_f32_bf16 v23, v153, v5
v_dot2c_f32_bf16 v24, v157, v5
v_dot2c_f32_bf16 v25, v161, v5
v_dot2c_f32_bf16 v22, v150, v6
v_dot2c_f32_bf16 v23, v154, v6
v_dot2c_f32_bf16 v24, v158, v6
v_dot2c_f32_bf16 v25, v162, v6
v_dot2c_f32_bf16 v22, v151, v7
v_dot2c_f32_bf16 v23, v155, v7
v_dot2c_f32_bf16 v24, v159, v7
v_dot2c_f32_bf16 v25, v163, v7
v_add_f32_dpp v26, v22, v22 row_ror:8 row_mask:0xf bank_mask:0x3
v_add_f32_dpp v27, v23, v23 row_ror:8 row_mask:0xf bank_mask:0x3
s_nop 0
v_add_f32_dpp v26, v24, v24 row_ror:8 row_mask:0xf bank_mask:0xc
v_add_f32_dpp v27, v25, v25 row_ror:8 row_mask:0xf bank_mask:0xc
s_nop 0
v_add_f32_dpp v28, v26, v26 row_half_mirror row_mask:0xf bank_mask:0x5
s_nop 1
v_add_f32_dpp v28, v27, v27 row_half_mirror row_mask:0xf bank_mask:0xa
s_nop 1
v_add_f32_dpp v28, v28, v28 quad_perm:[1,0,3,2] row_mask:0xf bank_mask:0xf
s_nop 1
v_add_f32_dpp v28, v28, v28 quad_perm:[2,3,0,1] row_mask:0xf bank_mask:0xf
v_cvt_pk_bf16_f32 v28, v28, v28
v_and_b32 v28, s62, v28
v_mul_f32 v28, s60, v28
v_cvt_pk_bf16_f32 v28, v28, v28
v_and_b32 v28, s62, v28
s_nop 1
v_max_f32_dpp v29, v28, v28 row_ror:8 row_mask:0xf bank_mask:0xf
s_nop 1
v_max_f32_dpp v29, v29, v29 row_ror:4 row_mask:0xf bank_mask:0xf
v_max_f32 v29, v29, v16
v_sub_f32 v30, v16, v29
v_sub_f32 v31, v28, v29
v_mov_b32 v16, v29
v_mul_f32 v30, s61, v30
v_mul_f32 v31, s61, v31
v_exp_f32 v30, v30
v_exp_f32 v31, v31
s_nop 0
v_fma_f32 v17, v17, v30, v31
v_cvt_pk_bf16_f32 v32, v31, 0
v_cvt_pk_bf16_f32 v33, 0, v31
v_mul_f32 v8, v8, v30
v_mul_f32 v9, v9, v30
v_mul_f32 v10, v10, v30
v_mul_f32 v11, v11, v30
v_mul_f32 v12, v12, v30
v_mul_f32 v13, v13, v30
v_mul_f32 v14, v14, v30
v_mul_f32 v15, v15, v30
s_waitcnt vmcnt(0)
v_dot2c_f32_bf16_dpp v8, v32, v164 row_newbcast:0 row_mask:0xf bank_mask:0xf
v_dot2c_f32_bf16_dpp v9, v33, v164 row_newbcast:0 row_mask:0xf bank_mask:0xf
v_dot2c_f32_bf16_dpp v10, v32, v165 row_newbcast:0 row_mask:0xf bank_mask:0xf
v_dot2c_f32_bf16_dpp v11, v33, v165 row_newbcast:0 row_mask:0xf bank_mask:0xf
v_dot2c_f32_bf16_dpp v12, v32, v166 row_newbcast:0 row_mask:0xf bank_mask:0xf
v_dot2c_f32_bf16_dpp v13, v33, v166 row_newbcast:0 row_mask:0xf bank_mask:0xf
v_dot2c_f32_bf16_dpp v14, v32, v167 row_newbcast:0 row_mask:0xf bank_mask:0xf
v_dot2c_f32_bf16_dpp v15, v33, v167 row_newbcast:0 row_mask:0xf bank_mask:0xf
v_dot2c_f32_bf16_dpp v8, v32, v168 row_newbcast:4 row_mask:0xf bank_mask:0xf
v_dot2c_f32_bf16_dpp v9, v33, v168 row_newbcast:4 row_mask:0xf bank_mask:0xf
v_dot2c_f32_bf16_dpp v10, v32, v169 row_newbcast:4 row_mask:0xf bank_mask:0xf
v_dot2c_f32_bf16_dpp v11, v33, v169 row_newbcast:4 row_mask:0xf bank_mask:0xf
v_dot2c_f32_bf16_dpp v12, v32, v170 row_newbcast:4 row_mask:0xf bank_mask:0xf
v_dot2c_f32_bf16_dpp v13, v33, v170 row_newbcast:4 row_mask:0xf bank_mask:0xf
v_dot2c_f32_bf16_dpp v14, v32, v171 row_newbcast:4 row_mask:0xf bank_mask:0xf
v_dot2c_f32_bf16_dpp v15, v33, v171 row_newbcast:4 row_mask:0xf bank_mask:0xf
v_dot2c_f32_bf16_dpp v8, v32, v172 row_newbcast:8 row_mask:0xf bank_mask:0xf
v_dot2c_f32_bf16_dpp v9, v33, v172 row_newbcast:8 row_mask:0xf bank_mask:0xf
v_dot2c_f32_bf16_dpp v10, v32, v173 row_newbcast:8 row_mask:0xf bank_mask:0xf
v_dot2c_f32_bf16_dpp v11, v33, v173 row_newbcast:8 row_mask:0xf bank_mask:0xf
v_dot2c_f32_bf16_dpp v12, v32, v174 row_newbcast:8 row_mask:0xf bank_mask:0xf
v_dot2c_f32_bf16_dpp v13, v33, v174 row_newbcast:8 row_mask:0xf bank_mask:0xf
v_dot2c_f32_bf16_dpp v14, v32, v175 row_newbcast:8 row_mask:0xf bank_mask:0xf
v_dot2c_f32_bf16_dpp v15, v33, v175 row_newbcast:8 row_mask:0xf bank_mask:0xf
v_dot2c_f32_bf16_dpp v8, v32, v176 row_newbcast:12 row_mask:0xf bank_mask:0xf
v_dot2c_f32_bf16_dpp v9, v33, v176 row_newbcast:12 row_mask:0xf bank_mask:0xf
v_dot2c_f32_bf16_dpp v10, v32, v177 row_newbcast:12 row_mask:0xf bank_mask:0xf
v_dot2c_f32_bf16_dpp v11, v33, v177 row_newbcast:12 row_mask:0xf bank_mask:0xf
v_dot2c_f32_bf16_dpp v12, v32, v178 row_newbcast:12 row_mask:0xf bank_mask:0xf
v_dot2c_f32_bf16_dpp v13, v33, v178 row_newbcast:12 row_mask:0xf bank_mask:0xf
v_dot2c_f32_bf16_dpp v14, v32, v179 row_newbcast:12 row_mask:0xf bank_mask:0xf
v_dot2c_f32_bf16_dpp v15, v33, v179 row_newbcast:12 row_mask:0xf bank_mask:0xf
v_mov_b32 v22, v16
v_mov_b32 v23, v22
s_nop 1
v_permlane16_swap_b32 v22, v23
v_max_f32 v22, v22, v23
v_mov_b32 v23, v22
s_nop 1
v_permlane32_swap_b32 v22, v23
v_max_f32 v22, v22, v23
v_sub_f32 v24, v16, v22
v_mul_f32 v24, s61, v24
v_exp_f32 v24, v24
s_nop 0
v_mul_f32 v17, v17, v24
v_mul_f32 v8, v8, v24
v_mul_f32 v9, v9, v24
v_mul_f32 v10, v10, v24
v_mul_f32 v11, v11, v24
v_mul_f32 v12, v12, v24
v_mul_f32 v13, v13, v24
v_mul_f32 v14, v14, v24
v_mul_f32 v15, v15, v24
v_add_f32_dpp v17, v17, v17 row_ror:8 row_mask:0xf bank_mask:0xf
v_permlane32_swap_b32 v8, v12
v_permlane32_swap_b32 v9, v13
v_permlane32_swap_b32 v10, v14
v_permlane32_swap_b32 v11, v15
v_add_f32 v8, v8, v12
v_add_f32 v9, v9, v13
v_add_f32 v10, v10, v14
v_add_f32 v11, v11, v15
s_nop 0
v_permlane16_swap_b32 v8, v10
v_permlane16_swap_b32 v9, v11
v_add_f32 v8, v8, v10
v_add_f32 v9, v9, v11
v_add_f32_dpp v17, v17, v17 row_ror:4 row_mask:0xf bank_mask:0xf
v_mov_b32 v23, v17
s_nop 1
v_permlane16_swap_b32 v17, v23
v_add_f32 v17, v17, v23
v_mov_b32 v23, v17
s_nop 1
v_permlane32_swap_b32 v17, v23
v_add_f32 v17, v17, v23
ds_write_b64 v118, v[8:9] offset:5120
v_mov_b32 v23, v17
s_mov_b64 exec, 1
ds_write_b64 v119, v[22:23] offset:9216
s_mov_b64 exec, -1
v_mov_b32 v12, 0
v_mov_b32 v13, 0
v_mov_b32 v14, 0
v_mov_b32 v15, 0
s_waitcnt lgkmcnt(0)
s_barrier
s_cmp_ge_u32 s48, 4
s_cbranch_scc1 L_noffnst
global_store_dwordx4 v136, v[132:135], s[22:23] sc1
L_noffnst:
L_E2:
ds_read_b64 v[28:29], v117 offset:9216
ds_read_b64 v[30:31], v116 offset:5120
ds_read_b64 v[32:33], v116 offset:5632
ds_read_b64 v[34:35], v116 offset:6144
ds_read_b64 v[36:37], v116 offset:6656
ds_read_b64 v[38:39], v116 offset:7168
ds_read_b64 v[40:41], v116 offset:7680
ds_read_b64 v[42:43], v116 offset:8192
ds_read_b64 v[44:45], v116 offset:8704
s_waitcnt lgkmcnt(8)
v_max_f32_dpp v22, v28, v28 quad_perm:[1,0,3,2] row_mask:0xf bank_mask:0xf
s_nop 1
v_max_f32_dpp v22, v22, v22 quad_perm:[2,3,0,1] row_mask:0xf bank_mask:0xf
s_nop 1
v_max_f32_dpp v22, v22, v22 row_half_mirror row_mask:0xf bank_mask:0xf
v_sub_f32 v23, v28, v22
v_mul_f32 v23, s61, v23
v_exp_f32 v23, v23
s_nop 0
v_mul_f32 v24, v29, v23
s_waitcnt lgkmcnt(0)
v_mul_f32_dpp v46, v23, v30 row_newbcast:0 row_mask:0xf bank_mask:0xf
v_mul_f32_dpp v47, v23, v31 row_newbcast:0 row_mask:0xf bank_mask:0xf
v_add_f32_dpp v24, v24, v24 quad_perm:[1,0,3,2] row_mask:0xf bank_mask:0xf
v_fmac_f32_dpp v46, v23, v32 row_newbcast:1 row_mask:0xf bank_mask:0xf
v_fmac_f32_dpp v47, v23, v33 row_newbcast:1 row_mask:0xf bank_mask:0xf
s_nop 0
v_fmac_f32_dpp v46, v23, v34 row_newbcast:2 row_mask:0xf bank_mask:0xf
v_fmac_f32_dpp v47, v23, v35 row_newbcast:2 row_mask:0xf bank_mask:0xf
v_add_f32_dpp v24, v24, v24 quad_perm:[2,3,0,1] row_mask:0xf bank_mask:0xf
v_fmac_f32_dpp v46, v23, v36 row_newbcast:3 row_mask:0xf bank_mask:0xf
v_fmac_f32_dpp v47, v23, v37 row_newbcast:3 row_mask:0xf bank_mask:0xf
s_nop 0
v_fmac_f32_dpp v46, v23, v38 row_newbcast:4 row_mask:0xf bank_mask:0xf
v_fmac_f32_dpp v47, v23, v39 row_newbcast:4 row_mask:0xf bank_mask:0xf
v_add_f32_dpp v24, v24, v24 row_half_mirror row_mask:0xf bank_mask:0xf
v_fmac_f32_dpp v46, v23, v40 row_newbcast:5 row_mask:0xf bank_mask:0xf
v_fmac_f32_dpp v47, v23, v41 row_newbcast:5 row_mask:0xf bank_mask:0xf
s_nop 0
v_fmac_f32_dpp v46, v23, v42 row_newbcast:6 row_mask:0xf bank_mask:0xf
v_fmac_f32_dpp v47, v23, v43 row_newbcast:6 row_mask:0xf bank_mask:0xf
s_nop 0
v_fmac_f32_dpp v46, v23, v44 row_newbcast:7 row_mask:0xf bank_mask:0xf
v_fmac_f32_dpp v47, v23, v45 row_newbcast:7 row_mask:0xf bank_mask:0xf
v_cvt_pk_bf16_f32 v25, v46, v47
s_nop 1
v_dot2c_f32_bf16_dpp v12, v25, v112 row_newbcast:0 row_mask:0xf bank_mask:0xf
v_dot2c_f32_bf16_dpp v13, v25, v50 row_newbcast:0 row_mask:0xf bank_mask:0xf
v_dot2c_f32_bf16_dpp v14, v25, v48 row_newbcast:0 row_mask:0xf bank_mask:0xf
v_dot2c_f32_bf16_dpp v15, v25, v51 row_newbcast:0 row_mask:0xf bank_mask:0xf
v_dot2c_f32_bf16_dpp v12, v25, v49 row_newbcast:1 row_mask:0xf bank_mask:0xf
v_dot2c_f32_bf16_dpp v13, v25, v54 row_newbcast:1 row_mask:0xf bank_mask:0xf
v_dot2c_f32_bf16_dpp v14, v25, v52 row_newbcast:1 row_mask:0xf bank_mask:0xf
v_dot2c_f32_bf16_dpp v15, v25, v55 row_newbcast:1 row_mask:0xf bank_mask:0xf
v_dot2c_f32_bf16_dpp v12, v25, v53 row_newbcast:2 row_mask:0xf bank_mask:0xf
v_dot2c_f32_bf16_dpp v13, v25, v58 row_newbcast:2 row_mask:0xf bank_mask:0xf
v_dot2c_f32_bf16_dpp v14, v25, v56 row_newbcast:2 row_mask:0xf bank_mask:0xf
v_dot2c_f32_bf16_dpp v15, v25, v59 row_newbcast:2 row_mask:0xf bank_mask:0xf
v_dot2c_f32_bf16_dpp v12, v25, v57 row_newbcast:3 row_mask:0xf bank_mask:0xf
v_dot2c_f32_bf16_dpp v13, v25, v62 row_newbcast:3 row_mask:0xf bank_mask:0xf
v_dot2c_f32_bf16_dpp v14, v25, v60 row_newbcast:3 row_mask:0xf bank_mask:0xf
v_dot2c_f32_bf16_dpp v15, v25, v63 row_newbcast:3 row_mask:0xf bank_mask:0xf
v_dot2c_f32_bf16_dpp v12, v25, v61 row_newbcast:4 row_mask:0xf bank_mask:0xf
v_dot2c_f32_bf16_dpp v13, v25, v66 row_newbcast:4 row_mask:0xf bank_mask:0xf
v_dot2c_f32_bf16_dpp v14, v25, v64 row_newbcast:4 row_mask:0xf bank_mask:0xf
v_dot2c_f32_bf16_dpp v15, v25, v67 row_newbcast:4 row_mask:0xf bank_mask:0xf
v_dot2c_f32_bf16_dpp v12, v25, v65 row_newbcast:5 row_mask:0xf bank_mask:0xf
v_dot2c_f32_bf16_dpp v13, v25, v70 row_newbcast:5 row_mask:0xf bank_mask:0xf
v_dot2c_f32_bf16_dpp v14, v25, v68 row_newbcast:5 row_mask:0xf bank_mask:0xf
v_dot2c_f32_bf16_dpp v15, v25, v71 row_newbcast:5 row_mask:0xf bank_mask:0xf
v_dot2c_f32_bf16_dpp v12, v25, v69 row_newbcast:6 row_mask:0xf bank_mask:0xf
v_dot2c_f32_bf16_dpp v13, v25, v74 row_newbcast:6 row_mask:0xf bank_mask:0xf
v_dot2c_f32_bf16_dpp v14, v25, v72 row_newbcast:6 row_mask:0xf bank_mask:0xf
v_dot2c_f32_bf16_dpp v15, v25, v75 row_newbcast:6 row_mask:0xf bank_mask:0xf
v_dot2c_f32_bf16_dpp v12, v25, v73 row_newbcast:7 row_mask:0xf bank_mask:0xf
v_dot2c_f32_bf16_dpp v13, v25, v78 row_newbcast:7 row_mask:0xf bank_mask:0xf
v_dot2c_f32_bf16_dpp v14, v25, v76 row_newbcast:7 row_mask:0xf bank_mask:0xf
v_dot2c_f32_bf16_dpp v15, v25, v79 row_newbcast:7 row_mask:0xf bank_mask:0xf
v_dot2c_f32_bf16_dpp v12, v25, v77 row_newbcast:8 row_mask:0xf bank_mask:0xf
v_dot2c_f32_bf16_dpp v13, v25, v82 row_newbcast:8 row_mask:0xf bank_mask:0xf
v_dot2c_f32_bf16_dpp v14, v25, v80 row_newbcast:8 row_mask:0xf bank_mask:0xf
v_dot2c_f32_bf16_dpp v15, v25, v83 row_newbcast:8 row_mask:0xf bank_mask:0xf
v_dot2c_f32_bf16_dpp v12, v25, v81 row_newbcast:9 row_mask:0xf bank_mask:0xf
v_dot2c_f32_bf16_dpp v13, v25, v86 row_newbcast:9 row_mask:0xf bank_mask:0xf
v_dot2c_f32_bf16_dpp v14, v25, v84 row_newbcast:9 row_mask:0xf bank_mask:0xf
v_dot2c_f32_bf16_dpp v15, v25, v87 row_newbcast:9 row_mask:0xf bank_mask:0xf
v_dot2c_f32_bf16_dpp v12, v25, v85 row_newbcast:10 row_mask:0xf bank_mask:0xf
v_dot2c_f32_bf16_dpp v13, v25, v90 row_newbcast:10 row_mask:0xf bank_mask:0xf
v_dot2c_f32_bf16_dpp v14, v25, v88 row_newbcast:10 row_mask:0xf bank_mask:0xf
v_dot2c_f32_bf16_dpp v15, v25, v91 row_newbcast:10 row_mask:0xf bank_mask:0xf
v_dot2c_f32_bf16_dpp v12, v25, v89 row_newbcast:11 row_mask:0xf bank_mask:0xf
v_dot2c_f32_bf16_dpp v13, v25, v94 row_newbcast:11 row_mask:0xf bank_mask:0xf
v_dot2c_f32_bf16_dpp v14, v25, v92 row_newbcast:11 row_mask:0xf bank_mask:0xf
v_dot2c_f32_bf16_dpp v15, v25, v95 row_newbcast:11 row_mask:0xf bank_mask:0xf
v_dot2c_f32_bf16_dpp v12, v25, v93 row_newbcast:12 row_mask:0xf bank_mask:0xf
v_dot2c_f32_bf16_dpp v13, v25, v98 row_newbcast:12 row_mask:0xf bank_mask:0xf
v_dot2c_f32_bf16_dpp v14, v25, v96 row_newbcast:12 row_mask:0xf bank_mask:0xf
v_dot2c_f32_bf16_dpp v15, v25, v99 row_newbcast:12 row_mask:0xf bank_mask:0xf
v_dot2c_f32_bf16_dpp v12, v25, v97 row_newbcast:13 row_mask:0xf bank_mask:0xf
v_dot2c_f32_bf16_dpp v13, v25, v102 row_newbcast:13 row_mask:0xf bank_mask:0xf
v_dot2c_f32_bf16_dpp v14, v25, v100 row_newbcast:13 row_mask:0xf bank_mask:0xf
v_dot2c_f32_bf16_dpp v15, v25, v103 row_newbcast:13 row_mask:0xf bank_mask:0xf
v_dot2c_f32_bf16_dpp v12, v25, v101 row_newbcast:14 row_mask:0xf bank_mask:0xf
v_dot2c_f32_bf16_dpp v13, v25, v106 row_newbcast:14 row_mask:0xf bank_mask:0xf
v_dot2c_f32_bf16_dpp v14, v25, v104 row_newbcast:14 row_mask:0xf bank_mask:0xf
v_dot2c_f32_bf16_dpp v15, v25, v107 row_newbcast:14 row_mask:0xf bank_mask:0xf
v_dot2c_f32_bf16_dpp v12, v25, v105 row_newbcast:15 row_mask:0xf bank_mask:0xf
v_dot2c_f32_bf16_dpp v13, v25, v110 row_newbcast:15 row_mask:0xf bank_mask:0xf
v_dot2c_f32_bf16_dpp v14, v25, v108 row_newbcast:15 row_mask:0xf bank_mask:0xf
v_dot2c_f32_bf16_dpp v15, v25, v111 row_newbcast:15 row_mask:0xf bank_mask:0xf
s_nop 1
v_permlane32_swap_b32 v12, v14
v_permlane32_swap_b32 v13, v15
v_add_f32 v12, v12, v14
v_add_f32 v13, v13, v15
v_mov_b32 v26, v12
v_mov_b32 v27, v13
s_nop 0
v_permlane16_swap_b32 v12, v26
v_permlane16_swap_b32 v13, v27
v_add_f32 v12, v12, v26
v_add_f32 v13, v13, v27
v_cndmask_b32 v14, v24, v22, s[16:17]
v_mov_b32 v15, s63
s_mov_b32 exec_lo, 0xffff
s_mov_b32 exec_hi, 0xffff
global_store_dwordx4 v115, v[12:15], s[22:23] sc1
s_mov_b64 exec, -1
s_mov_b32 s67, 0
L_poll:
global_load_dwordx4 v[24:27], v120, s[22:23] sc1
s_waitcnt vmcnt(0)
v_cmp_ne_u32 vcc, s63, v27
s_and_b64 exec, exec, vcc
s_cbranch_execz L_got
s_add_u32 s67, s67, 1
s_cmp_lt_u32 s67, 20000
s_cbranch_scc0 L_got
s_sleep 1
s_branch L_poll
L_got:
s_mov_b64 exec, -1
L_scale:
s_cmp_ge_u32 s48, 4
s_cbranch_scc1 L_noscale
s_nop 1
v_mov_b32_dpp v28, v26 quad_perm:[0,0,0,0] row_mask:0xf bank_mask:0xf
v_mov_b32_dpp v29, v26 quad_perm:[1,1,1,1] row_mask:0xf bank_mask:0xf
s_nop 0
v_max_f32_dpp v30, v28, v28 row_half_mirror row_mask:0xf bank_mask:0xf
v_sub_f32 v31, v28, v30
v_mul_f32 v31, s61, v31
v_exp_f32 v31, v31
s_nop 0
v_mul_f32 v29, v29, v31
s_nop 1
v_add_f32_dpp v29, v29, v29 row_half_mirror row_mask:0xf bank_mask:0xf
v_rcp_f32 v29, v29
s_nop 0
v_mul_f32 v31, v31, v29
v_mul_f32 v24, v24, v31
v_mul_f32 v25, v25, v31
L_noscale:
s_nop 1
v_add_f32_dpp v24, v24, v24 row_ror:4 row_mask:0xf bank_mask:0xf
v_add_f32_dpp v25, v25, v25 row_ror:4 row_mask:0xf bank_mask:0xf
s_nop 0
v_add_f32_dpp v24, v24, v24 row_ror:8 row_mask:0xf bank_mask:0xf
v_add_f32_dpp v25, v25, v25 row_ror:8 row_mask:0xf bank_mask:0xf
s_nop 1
v_permlane32_swap_b32 v24, v25
v_add_f32 v24, v24, v25
v_mov_b32 v25, v24
s_nop 1
v_permlane16_swap_b32 v24, v25
v_add_f32 v24, v24, v25
s_and_b64 exec, exec, s[14:15]
ds_write_b32 v121, v24 offset:9280
s_mov_b64 exec, -1
s_waitcnt lgkmcnt(0)
s_barrier
s_cmp_lg_u32 s48, 0
s_cbranch_scc1 L_fin
L_final:
ds_read_b128 v[30:33], v122 offset:9280
ds_read_b128 v[34:37], v122 offset:9296
v_lshlrev_b32 v22, 16, v3
s_waitcnt lgkmcnt(0)
v_add_f32 v30, v30, v31
v_add_f32 v32, v32, v33
v_add_f32 v34, v34, v35
v_add_f32 v36, v36, v37
v_add_f32 v30, v30, v32
v_add_f32 v34, v34, v36
v_cvt_pk_bf16_f32 v30, v30, v30
v_and_b32 v30, s62, v30
v_cvt_pk_bf16_f32 v34, v34, v34
v_and_b32 v34, s62, v34
v_add_f32 v30, v22, v30
v_cvt_pk_bf16_f32 v30, v30, v30
v_and_b32 v30, s62, v30
v_add_f32 v30, v30, v34
v_cvt_pk_bf16_f32 v30, v30, v30
s_mov_b64 exec, 0xff
global_store_short v123, v30, s[20:21]
s_cmp_lg_u32 s56, 0
s_cbranch_scc1 L_noep
s_add_u32 s59, s64, 1
s_lshl_b32 s65, s53, 8
v_mov_b32 v31, s59
v_mov_b32 v32, s65
s_mov_b64 exec, 1
global_store_dword v32, v31, s[22:23]
L_noep:
L_fin:
L_end:
s_endpgm
.section .rodata,"a"
.p2align 6
.amdhsa_kernel parallel_sum__mha_block_cached__dense_activation_silu__decode_kernel
  .amdhsa_next_free_vgpr 244
  .amdhsa_next_free_sgpr 102
  .amdhsa_accum_offset 244
  .amdhsa_group_segment_fixed_size 0
  .amdhsa_kernarg_size 88
  .amdhsa_user_sgpr_count 2
  .amdhsa_user_sgpr_kernarg_segment_ptr 1
  .amdhsa_system_sgpr_workgroup_id_x 1
  .amdhsa_float_denorm_mode_32 3
  .amdhsa_float_denorm_mode_16_64 3
.end_amdhsa_kernel
```
